```python
import torch

def _softmax(x, axis=-1):
    return torch.softmax(x, dim=axis)
def _gelu(x):
    return torch.nn.functional.gelu(x, approximate="tanh")
def _silu(x):
    return torch.nn.functional.silu(x)
def _sigmoid(x):
    return torch.sigmoid(x)
def _layernorm(x, axis=-1, eps=1e-5):
    m = x.mean(dim=axis, keepdim=True)
    v = x.var(dim=axis, keepdim=True, unbiased=False)
    return (x - m) / torch.sqrt(v + eps)
def _scatter_add(tgt, idx, src, axis=0):
    return tgt.clone().index_add_(axis, idx, src)
def _segment_sum(src, seg, n):
    out = torch.zeros((n,) + src.shape[1:], dtype=src.dtype)
    return out.index_add_(0, seg, src)
def _pad(x, pw):
    flat = tuple(v for pair in reversed(pw) for v in pair)
    return torch.nn.functional.pad(x, flat)

kernel_name = 'concat_heads__mha_block__spectral_fnet__prompt'

def setup_inputs():

    _w = (lambda a: (lambda t: t.to(torch.bfloat16) if t.is_floating_point() else t)(torch.as_tensor(a)))
    def _A_setup():
        B, S, D, H = 1, 2048, 640, 32
        return {
            "x": _w((lambda *s: torch.randn(*s, dtype=torch.bfloat16) * 0.2)(B, S, D)),
            "wqkv": _w((lambda *s: torch.randn(*s, dtype=torch.bfloat16) * 0.8)(D, 3 * D)),
            "wo": _w((lambda *s: torch.randn(*s, dtype=torch.bfloat16) * 0.2)(D, D)),
        }
    _A_in = _A_setup()

    def _B_setup():
        B, S, D = 1, 2048, 640
        ns = torch.arange(S)[:, None] * torch.arange(S)[None, :]
        nd = torch.arange(D)[:, None] * torch.arange(D)[None, :]
        Ws_re = torch.cos(-2.0 * torch.pi * ns / S).to(float)
        Ws_im = torch.sin(-2.0 * torch.pi * ns / S).to(float)
        Wd_re = torch.cos(-2.0 * torch.pi * nd / D).to(float)
        Wd_im = torch.sin(-2.0 * torch.pi * nd / D).to(float)
        return {
            "x": _w((lambda *s: torch.randn(*s, dtype=torch.bfloat16) * 0.05)(B, S, D)),
            "dft_seq_re": _w(Ws_re),
            "dft_seq_im": _w(Ws_im),
            "dft_hid_re": _w(Wd_re),
            "dft_hid_im": _w(Wd_im),
        }
    _B_in = _B_setup()

    return {
        "A_x": _A_in["x"],
        "A_wqkv": _A_in["wqkv"],
        "A_wo": _A_in["wo"],
        "B_x": _B_in["x"],
        "B_dft_seq_re": _B_in["dft_seq_re"],
        "B_dft_seq_im": _B_in["dft_seq_im"],
        "B_dft_hid_re": _B_in["dft_hid_re"],
        "B_dft_hid_im": _B_in["dft_hid_im"],
    }

def reference(A_x, A_wqkv, A_wo, B_x, B_dft_seq_re, B_dft_seq_im, B_dft_hid_re, B_dft_hid_im):
    def _A_ref(x, wqkv, wo):
        B, S, D = x.shape
        H = 32
        Dh = D // H
        qkv = (lambda x, *d: x.permute(*d))((x @ wqkv).reshape(B, S, 3, H, Dh), 2, 0, 3, 1, 4)
        q, k, v = qkv[0], qkv[1], qkv[2]
        scores = torch.einsum("bhqd,bhkd->bhqk", q, k) * (Dh ** -0.5)
        p = _softmax(scores, axis=-1)
        o = torch.einsum("bhqk,bhkd->bhqd", p, v)
        return (lambda x, *d: x.permute(*d))(o, 0, 2, 1, 3).reshape(B, S, D) @ wo

    def _B_ref(x, dft_seq_re, dft_seq_im, dft_hid_re, dft_hid_im):
        a = torch.einsum("bsd,ed->bse", x, dft_hid_re)
        b = torch.einsum("bsd,ed->bse", x, dft_hid_im)
        y = torch.einsum("ts,bse->bte", dft_seq_re, a) - torch.einsum("ts,bse->bte", dft_seq_im, b)
        return y

    a = _A_ref(A_x, A_wqkv, A_wo)
    b = _B_ref(B_x, B_dft_seq_re, B_dft_seq_im, B_dft_hid_re, B_dft_hid_im)
    return torch.concatenate([a, b], axis=-1)
```

```asm
; @launch grid=(256,1,1) block=(512,1,1) lds=163840
.amdgcn_target "amdgcn-amd-amdhsa--gfx950"
.text
.globl concat_heads__mha_block__spectral_fnet__prompt_kernel
.p2align 8
.type concat_heads__mha_block__spectral_fnet__prompt_kernel,@function
concat_heads__mha_block__spectral_fnet__prompt_kernel:
    s_cmp_ge_u32 s2, 256
    s_cbranch_scc1 L_exit
    s_load_dwordx8 s[4:11], s[0:1], 0
    s_load_dwordx4 s[12:15], s[0:1], 64
    s_load_dwordx2 s[16:17], s[0:1], 80
    v_lshrrev_b32 v1, 6, v0
    s_and_b32 s24, s2, 7
    v_readfirstlane_b32 s3, v1
    s_lshr_b32 s25, s2, 3
    v_and_b32 v1, 63, v0
    s_and_b32 s26, s24, 1
    s_lshl_b32 s26, s26, 3
    s_and_b32 s27, s25, 7
    s_add_u32 s26, s26, s27
    s_lshr_b32 s27, s25, 3
    s_lshl_b32 s27, s27, 2
    s_lshr_b32 s40, s24, 1
    s_add_u32 s27, s27, s40
    s_cmp_ge_u32 s25, 24
    s_cselect_b32 s40, 0, s3
    s_cmp_lt_u32 s40, 4
    s_cbranch_scc1 L_other
L_loader:
    s_sub_u32 s44, s3, 4
    v_lshrrev_b32 v2, 3, v1
    s_lshl_b32 s40, s44, 3
    v_add_u32 v2, s40, v2
    v_mul_u32_u24 v2, 1280, v2
    v_lshrrev_b32 v3, 4, v1
    s_and_b32 s40, s44, 1
    s_lshl_b32 s40, s40, 2
    v_or_b32 v4, s40, v3
    v_and_b32 v5, 7, v1
    v_xor_b32 v4, v4, v5
    v_lshl_add_u32 v10, v4, 4, v2
    s_lshl_b32 s45, s44, 10
    s_lshr_b32 s40, s25, 3
    s_add_u32 s40, s40, s25
    s_and_b32 s40, s40, 1
    s_mul_i32 s40, s40, 6
    s_mul_i32 s41, s24, 3
    s_add_u32 s40, s40, s41
    s_mul_i32 s41, s40, 6554
    s_lshr_b32 s41, s41, 16
    s_mul_i32 s41, s41, 10
    s_sub_u32 s47, s40, s41
    s_lshl_b32 s40, s44, 4
    v_lshrrev_b32 v2, 2, v1
    v_add_u32 v2, s40, v2
    v_mul_u32_u24 v2, 3840, v2
    v_and_b32 v3, 3, v1
    v_lshrrev_b32 v4, 5, v1
    v_lshlrev_b32 v4, 1, v4
    v_xor_b32 v3, v3, v4
    v_lshl_add_u32 v11, v3, 4, v2
    s_mul_i32 s46, s44, 5120
    s_mul_i32 s50, s26, 163840
    s_mul_i32 s51, s27, 320
    s_sub_u32 s52, 2457600, s51
    s_waitcnt lgkmcnt(0)
    s_add_u32 s28, s4, s50
    s_addc_u32 s29, s5, 0
    s_mov_b32 s30, 163840
    s_mov_b32 s31, 0x00020000
    s_lshl_b32 s48, s47, 7
    s_add_u32 m0, s45, 0
    s_mul_i32 s49, s47, 245760
    buffer_load_dwordx4 v10, s[28:31], s48 offen lds
    s_add_u32 m0, s45, 4096
    s_add_u32 s48, s48, 40960
    buffer_load_dwordx4 v10, s[28:31], s48 offen lds
    s_add_u32 m0, s45, 8192
    s_add_u32 s48, s48, 40960
    buffer_load_dwordx4 v10, s[28:31], s48 offen lds
    s_add_u32 m0, s45, 12288
    s_add_u32 s48, s48, 40960
    buffer_load_dwordx4 v10, s[28:31], s48 offen lds
    s_add_u32 s32, s6, s51
    s_addc_u32 s33, s7, 0
    s_mov_b32 s34, s52
    s_mov_b32 s35, 0x00020000
    s_add_u32 m0, s46, 16384
    s_add_u32 s47, s47, 1
    buffer_load_dwordx4 v11, s[32:35], s49 offen offset:0 lds
    s_add_u32 m0, s46, 17344
    s_cmp_eq_u32 s47, 10
    s_cmov_b32 s47, 0
    buffer_load_dwordx4 v11, s[32:35], s49 offen offset:64 lds
    s_add_u32 m0, s46, 18304
    s_nop 0
    buffer_load_dwordx4 v11, s[32:35], s49 offen offset:128 lds
    s_add_u32 m0, s46, 19264
    s_nop 0
    buffer_load_dwordx4 v11, s[32:35], s49 offen offset:192 lds
    s_add_u32 m0, s46, 20224
    s_nop 0
    buffer_load_dwordx4 v11, s[32:35], s49 offen offset:256 lds
    s_lshl_b32 s48, s47, 7
    s_add_u32 m0, s45, 36864
    s_mul_i32 s49, s47, 245760
    buffer_load_dwordx4 v10, s[28:31], s48 offen lds
    s_add_u32 m0, s45, 40960
    s_add_u32 s48, s48, 40960
    buffer_load_dwordx4 v10, s[28:31], s48 offen lds
    s_add_u32 m0, s45, 45056
    s_add_u32 s48, s48, 40960
    buffer_load_dwordx4 v10, s[28:31], s48 offen lds
    s_add_u32 m0, s45, 49152
    s_add_u32 s48, s48, 40960
    buffer_load_dwordx4 v10, s[28:31], s48 offen lds
    s_add_u32 m0, s46, 53248
    s_add_u32 s47, s47, 1
    buffer_load_dwordx4 v11, s[32:35], s49 offen offset:0 lds
    s_add_u32 m0, s46, 54208
    s_cmp_eq_u32 s47, 10
    s_cmov_b32 s47, 0
    buffer_load_dwordx4 v11, s[32:35], s49 offen offset:64 lds
    s_add_u32 m0, s46, 55168
    s_nop 0
    buffer_load_dwordx4 v11, s[32:35], s49 offen offset:128 lds
    s_add_u32 m0, s46, 56128
    s_nop 0
    buffer_load_dwordx4 v11, s[32:35], s49 offen offset:192 lds
    s_add_u32 m0, s46, 57088
    s_nop 0
    buffer_load_dwordx4 v11, s[32:35], s49 offen offset:256 lds
    s_waitcnt vmcnt(9)
    s_barrier
    s_lshl_b32 s48, s47, 7
    s_add_u32 m0, s45, 73728
    s_mul_i32 s49, s47, 245760
    buffer_load_dwordx4 v10, s[28:31], s48 offen lds
    s_add_u32 m0, s45, 77824
    s_add_u32 s48, s48, 40960
    buffer_load_dwordx4 v10, s[28:31], s48 offen lds
    s_add_u32 m0, s45, 81920
    s_add_u32 s48, s48, 40960
    buffer_load_dwordx4 v10, s[28:31], s48 offen lds
    s_add_u32 m0, s45, 86016
    s_add_u32 s48, s48, 40960
    buffer_load_dwordx4 v10, s[28:31], s48 offen lds
    s_add_u32 m0, s46, 90112
    s_add_u32 s47, s47, 1
    buffer_load_dwordx4 v11, s[32:35], s49 offen offset:0 lds
    s_add_u32 m0, s46, 91072
    s_cmp_eq_u32 s47, 10
    s_cmov_b32 s47, 0
    buffer_load_dwordx4 v11, s[32:35], s49 offen offset:64 lds
    s_add_u32 m0, s46, 92032
    s_nop 0
    buffer_load_dwordx4 v11, s[32:35], s49 offen offset:128 lds
    s_add_u32 m0, s46, 92992
    s_nop 0
    buffer_load_dwordx4 v11, s[32:35], s49 offen offset:192 lds
    s_add_u32 m0, s46, 93952
    s_nop 0
    buffer_load_dwordx4 v11, s[32:35], s49 offen offset:256 lds
    s_waitcnt vmcnt(9)
    s_barrier
    s_lshl_b32 s48, s47, 7
    s_add_u32 m0, s45, 110592
    s_mul_i32 s49, s47, 245760
    buffer_load_dwordx4 v10, s[28:31], s48 offen lds
    s_add_u32 m0, s45, 114688
    s_add_u32 s48, s48, 40960
    buffer_load_dwordx4 v10, s[28:31], s48 offen lds
    s_add_u32 m0, s45, 118784
    s_add_u32 s48, s48, 40960
    buffer_load_dwordx4 v10, s[28:31], s48 offen lds
    s_add_u32 m0, s45, 122880
    s_add_u32 s48, s48, 40960
    buffer_load_dwordx4 v10, s[28:31], s48 offen lds
    s_add_u32 m0, s46, 126976
    s_add_u32 s47, s47, 1
    buffer_load_dwordx4 v11, s[32:35], s49 offen offset:0 lds
    s_add_u32 m0, s46, 127936
    s_cmp_eq_u32 s47, 10
    s_cmov_b32 s47, 0
    buffer_load_dwordx4 v11, s[32:35], s49 offen offset:64 lds
    s_add_u32 m0, s46, 128896
    s_nop 0
    buffer_load_dwordx4 v11, s[32:35], s49 offen offset:128 lds
    s_add_u32 m0, s46, 129856
    s_nop 0
    buffer_load_dwordx4 v11, s[32:35], s49 offen offset:192 lds
    s_add_u32 m0, s46, 130816
    s_nop 0
    buffer_load_dwordx4 v11, s[32:35], s49 offen offset:256 lds
    s_waitcnt vmcnt(9)
    s_barrier
    s_lshl_b32 s48, s47, 7
    s_add_u32 m0, s45, 0
    s_mul_i32 s49, s47, 245760
    buffer_load_dwordx4 v10, s[28:31], s48 offen lds
    s_add_u32 m0, s45, 4096
    s_add_u32 s48, s48, 40960
    buffer_load_dwordx4 v10, s[28:31], s48 offen lds
    s_add_u32 m0, s45, 8192
    s_add_u32 s48, s48, 40960
    buffer_load_dwordx4 v10, s[28:31], s48 offen lds
    s_add_u32 m0, s45, 12288
    s_add_u32 s48, s48, 40960
    buffer_load_dwordx4 v10, s[28:31], s48 offen lds
    s_add_u32 m0, s46, 16384
    s_add_u32 s47, s47, 1
    buffer_load_dwordx4 v11, s[32:35], s49 offen offset:0 lds
    s_add_u32 m0, s46, 17344
    s_cmp_eq_u32 s47, 10
    s_cmov_b32 s47, 0
    buffer_load_dwordx4 v11, s[32:35], s49 offen offset:64 lds
    s_add_u32 m0, s46, 18304
    s_nop 0
    buffer_load_dwordx4 v11, s[32:35], s49 offen offset:128 lds
    s_add_u32 m0, s46, 19264
    s_nop 0
    buffer_load_dwordx4 v11, s[32:35], s49 offen offset:192 lds
    s_add_u32 m0, s46, 20224
    s_nop 0
    buffer_load_dwordx4 v11, s[32:35], s49 offen offset:256 lds
    s_waitcnt vmcnt(9)
    s_barrier
    s_lshl_b32 s48, s47, 7
    s_add_u32 m0, s45, 36864
    s_mul_i32 s49, s47, 245760
    buffer_load_dwordx4 v10, s[28:31], s48 offen lds
    s_add_u32 m0, s45, 40960
    s_add_u32 s48, s48, 40960
    buffer_load_dwordx4 v10, s[28:31], s48 offen lds
    s_add_u32 m0, s45, 45056
    s_add_u32 s48, s48, 40960
    buffer_load_dwordx4 v10, s[28:31], s48 offen lds
    s_add_u32 m0, s45, 49152
    s_add_u32 s48, s48, 40960
    buffer_load_dwordx4 v10, s[28:31], s48 offen lds
    s_add_u32 m0, s46, 53248
    s_add_u32 s47, s47, 1
    buffer_load_dwordx4 v11, s[32:35], s49 offen offset:0 lds
    s_add_u32 m0, s46, 54208
    s_cmp_eq_u32 s47, 10
    s_cmov_b32 s47, 0
    buffer_load_dwordx4 v11, s[32:35], s49 offen offset:64 lds
    s_add_u32 m0, s46, 55168
    s_nop 0
    buffer_load_dwordx4 v11, s[32:35], s49 offen offset:128 lds
    s_add_u32 m0, s46, 56128
    s_nop 0
    buffer_load_dwordx4 v11, s[32:35], s49 offen offset:192 lds
    s_add_u32 m0, s46, 57088
    s_nop 0
    buffer_load_dwordx4 v11, s[32:35], s49 offen offset:256 lds
    s_waitcnt vmcnt(9)
    s_barrier
    s_lshl_b32 s48, s47, 7
    s_add_u32 m0, s45, 73728
    s_mul_i32 s49, s47, 245760
    buffer_load_dwordx4 v10, s[28:31], s48 offen lds
    s_add_u32 m0, s45, 77824
    s_add_u32 s48, s48, 40960
    buffer_load_dwordx4 v10, s[28:31], s48 offen lds
    s_add_u32 m0, s45, 81920
    s_add_u32 s48, s48, 40960
    buffer_load_dwordx4 v10, s[28:31], s48 offen lds
    s_add_u32 m0, s45, 86016
    s_add_u32 s48, s48, 40960
    buffer_load_dwordx4 v10, s[28:31], s48 offen lds
    s_add_u32 m0, s46, 90112
    s_add_u32 s47, s47, 1
    buffer_load_dwordx4 v11, s[32:35], s49 offen offset:0 lds
    s_add_u32 m0, s46, 91072
    s_cmp_eq_u32 s47, 10
    s_cmov_b32 s47, 0
    buffer_load_dwordx4 v11, s[32:35], s49 offen offset:64 lds
    s_add_u32 m0, s46, 92032
    s_nop 0
    buffer_load_dwordx4 v11, s[32:35], s49 offen offset:128 lds
    s_add_u32 m0, s46, 92992
    s_nop 0
    buffer_load_dwordx4 v11, s[32:35], s49 offen offset:192 lds
    s_add_u32 m0, s46, 93952
    s_nop 0
    buffer_load_dwordx4 v11, s[32:35], s49 offen offset:256 lds
    s_waitcnt vmcnt(9)
    s_barrier
    s_lshl_b32 s48, s47, 7
    s_add_u32 m0, s45, 110592
    s_mul_i32 s49, s47, 245760
    buffer_load_dwordx4 v10, s[28:31], s48 offen lds
    s_add_u32 m0, s45, 114688
    s_add_u32 s48, s48, 40960
    buffer_load_dwordx4 v10, s[28:31], s48 offen lds
    s_add_u32 m0, s45, 118784
    s_add_u32 s48, s48, 40960
    buffer_load_dwordx4 v10, s[28:31], s48 offen lds
    s_add_u32 m0, s45, 122880
    s_add_u32 s48, s48, 40960
    buffer_load_dwordx4 v10, s[28:31], s48 offen lds
    s_add_u32 m0, s46, 126976
    s_add_u32 s47, s47, 1
    buffer_load_dwordx4 v11, s[32:35], s49 offen offset:0 lds
    s_add_u32 m0, s46, 127936
    s_cmp_eq_u32 s47, 10
    s_cmov_b32 s47, 0
    buffer_load_dwordx4 v11, s[32:35], s49 offen offset:64 lds
    s_add_u32 m0, s46, 128896
    s_nop 0
    buffer_load_dwordx4 v11, s[32:35], s49 offen offset:128 lds
    s_add_u32 m0, s46, 129856
    s_nop 0
    buffer_load_dwordx4 v11, s[32:35], s49 offen offset:192 lds
    s_add_u32 m0, s46, 130816
    s_nop 0
    buffer_load_dwordx4 v11, s[32:35], s49 offen offset:256 lds
    s_waitcnt vmcnt(9)
    s_barrier
    s_lshl_b32 s48, s47, 7
    s_add_u32 m0, s45, 0
    s_mul_i32 s49, s47, 245760
    buffer_load_dwordx4 v10, s[28:31], s48 offen lds
    s_add_u32 m0, s45, 4096
    s_add_u32 s48, s48, 40960
    buffer_load_dwordx4 v10, s[28:31], s48 offen lds
    s_add_u32 m0, s45, 8192
    s_add_u32 s48, s48, 40960
    buffer_load_dwordx4 v10, s[28:31], s48 offen lds
    s_add_u32 m0, s45, 12288
    s_add_u32 s48, s48, 40960
    buffer_load_dwordx4 v10, s[28:31], s48 offen lds
    s_add_u32 m0, s46, 16384
    s_add_u32 s47, s47, 1
    buffer_load_dwordx4 v11, s[32:35], s49 offen offset:0 lds
    s_add_u32 m0, s46, 17344
    s_cmp_eq_u32 s47, 10
    s_cmov_b32 s47, 0
    buffer_load_dwordx4 v11, s[32:35], s49 offen offset:64 lds
    s_add_u32 m0, s46, 18304
    s_nop 0
    buffer_load_dwordx4 v11, s[32:35], s49 offen offset:128 lds
    s_add_u32 m0, s46, 19264
    s_nop 0
    buffer_load_dwordx4 v11, s[32:35], s49 offen offset:192 lds
    s_add_u32 m0, s46, 20224
    s_nop 0
    buffer_load_dwordx4 v11, s[32:35], s49 offen offset:256 lds
    s_waitcnt vmcnt(9)
    s_barrier
    s_lshl_b32 s48, s47, 7
    s_add_u32 m0, s45, 36864
    s_mul_i32 s49, s47, 245760
    buffer_load_dwordx4 v10, s[28:31], s48 offen lds
    s_add_u32 m0, s45, 40960
    s_add_u32 s48, s48, 40960
    buffer_load_dwordx4 v10, s[28:31], s48 offen lds
    s_add_u32 m0, s45, 45056
    s_add_u32 s48, s48, 40960
    buffer_load_dwordx4 v10, s[28:31], s48 offen lds
    s_add_u32 m0, s45, 49152
    s_add_u32 s48, s48, 40960
    buffer_load_dwordx4 v10, s[28:31], s48 offen lds
    s_add_u32 m0, s46, 53248
    s_add_u32 s47, s47, 1
    buffer_load_dwordx4 v11, s[32:35], s49 offen offset:0 lds
    s_add_u32 m0, s46, 54208
    s_cmp_eq_u32 s47, 10
    s_cmov_b32 s47, 0
    buffer_load_dwordx4 v11, s[32:35], s49 offen offset:64 lds
    s_add_u32 m0, s46, 55168
    s_nop 0
    buffer_load_dwordx4 v11, s[32:35], s49 offen offset:128 lds
    s_add_u32 m0, s46, 56128
    s_nop 0
    buffer_load_dwordx4 v11, s[32:35], s49 offen offset:192 lds
    s_add_u32 m0, s46, 57088
    s_nop 0
    buffer_load_dwordx4 v11, s[32:35], s49 offen offset:256 lds
    s_waitcnt vmcnt(9)
    s_barrier
    s_waitcnt vmcnt(0)
    s_barrier
    s_add_u32 s20, s16, 16777216
    s_addc_u32 s21, s17, 0
    s_mov_b32 s22, 196608
    s_mov_b32 s23, 0x00020000
    s_mov_b32 s28, s14
    s_mov_b32 s29, s15
    s_mov_b32 s30, 256
    s_mov_b32 s31, 0x00020000
    v_mov_b32 v2, 0
    s_mov_b32 s40, 200000
L_non_1:
    buffer_load_dwordx2 v[4:5], v2, s[28:31], 0 offen sc1
    s_waitcnt vmcnt(0)
    v_readfirstlane_b32 s18, v4
    v_readfirstlane_b32 s19, v5
    s_sub_u32 s40, s40, 1
    s_cmp_lg_u32 s18, 0
    s_cbranch_scc1 L_nonok_2
    s_cmp_eq_u32 s40, 0
    s_cbranch_scc1 L_nonok_2
    s_sleep 2
    s_branch L_non_1
L_nonok_2:
    s_branch L_A_done
L_other:
    s_waitcnt lgkmcnt(0)
    s_add_u32 s20, s16, 16777216
    s_addc_u32 s21, s17, 0
    s_mov_b32 s22, 196608
    s_mov_b32 s23, 0x00020000
    s_cmp_lg_u32 s3, 0
    s_cbranch_scc1 L_no_init
    v_mov_b32 v2, 160704
    v_mov_b32 v4, 0
    v_mov_b32 v5, 0
    ds_write_b64 v2, v[4:5] offset:0
    ds_write_b64 v2, v[4:5] offset:8
    ds_write_b64 v2, v[4:5] offset:16
    ds_write_b64 v2, v[4:5] offset:24
    ds_write_b64 v2, v[4:5] offset:32
    ds_write_b64 v2, v[4:5] offset:40
    ds_write_b64 v2, v[4:5] offset:48
    ds_write_b64 v2, v[4:5] offset:56
    s_cmp_lg_u32 s2, 0
    s_cbranch_scc1 L_no_nonce
    s_memrealtime s[40:41]
    s_mov_b32 s28, s14
    s_mov_b32 s29, s15
    s_mov_b32 s30, 256
    s_mov_b32 s31, 0x00020000
    s_waitcnt lgkmcnt(0)
    s_or_b32 s40, s40, 1
    v_mov_b32 v2, s40
    v_mov_b32 v3, s41
    buffer_store_dwordx2 v[2:3], v4, s[28:31], 0 offen sc1
L_no_nonce:
    s_waitcnt lgkmcnt(0)
L_no_init:
    s_cmp_ge_u32 s25, 24
    s_cbranch_scc1 L_prep
    s_cmp_lg_u32 s3, 1
    s_cbranch_scc1 L_no_code
    s_getpc_b64 s[40:41]
L_pc:
    s_sub_u32 s40, s40, L_pc-concat_heads__mha_block__spectral_fnet__prompt_kernel
    s_subb_u32 s41, s41, 0
    s_mul_i32 s42, s25, 1792
    v_lshlrev_b32 v2, 4, v1
    v_add_u32 v2, s42, v2
    v_min_u32 v2, L_exit-concat_heads__mha_block__spectral_fnet__prompt_kernel-1024-16, v2
    global_load_dwordx4 v[250:253], v2, s[40:41] offset:0
    global_load_dwordx4 v[250:253], v2, s[40:41] offset:1024
L_no_code:
L_compute:
    v_and_b32 v2, 15, v1
    v_lshrrev_b32 v3, 4, v1
    s_and_b32 s42, s3, 1
    s_lshr_b32 s43, s3, 1
    s_lshl_b32 s40, s42, 6
    v_add_u32 v4, s40, v2
    v_lshlrev_b32 v4, 7, v4
    v_lshrrev_b32 v5, 1, v2
    v_xor_b32 v5, v5, v3
    v_lshl_add_u32 v8, v5, 4, v4
    v_xor_b32 v9, 64, v8
    v_lshrrev_b32 v4, 5, v1
    v_mul_u32_u24 v4, 5120, v4
    v_and_b32 v5, 1, v3
    v_lshrrev_b32 v6, 2, v2
    v_lshl_add_u32 v6, v5, 3, v6
    v_lshl_add_u32 v4, v6, 6, v4
    v_add_u32 v4, 16384, v4
    v_lshlrev_b32 v5, 2, v5
    v_and_b32 v6, 3, v1
    s_mul_i32 s44, s43, 20
    s_lshl_b32 s45, s26, 2
    s_lshl_b32 s42, s42, 1
    s_add_u32 s42, s42, s45
    s_and_b32 s45, s27, 3
    s_lshl_b32 s45, s45, 3
    s_lshl_b32 s43, s43, 2
    s_add_u32 s43, s43, s45
    s_cmp_ge_u32 s27, 8
    s_cbranch_scc1 L_compute_v
    s_add_u32 s45, s44, 0
    v_add_u32 v7, s45, v6
    v_and_b32 v15, 7, v7
    v_xor_b32 v15, v15, v5
    v_lshl_add_u32 v15, v15, 3, v4
    v_lshrrev_b32 v7, 3, v7
    v_lshl_add_u32 v10, v7, 10, v15
    s_add_u32 s45, s44, 5
    v_add_u32 v7, s45, v6
    v_and_b32 v15, 7, v7
    v_xor_b32 v15, v15, v5
    v_lshl_add_u32 v15, v15, 3, v4
    v_lshrrev_b32 v7, 3, v7
    v_lshl_add_u32 v11, v7, 10, v15
    s_add_u32 s45, s44, 10
    v_add_u32 v7, s45, v6
    v_and_b32 v15, 7, v7
    v_xor_b32 v15, v15, v5
    v_lshl_add_u32 v15, v15, 3, v4
    v_lshrrev_b32 v7, 3, v7
    v_lshl_add_u32 v12, v7, 10, v15
    s_add_u32 s45, s44, 15
    v_add_u32 v7, s45, v6
    v_and_b32 v15, 7, v7
    v_xor_b32 v15, v15, v5
    v_lshl_add_u32 v15, v15, 3, v4
    v_lshrrev_b32 v7, 3, v7
    v_lshl_add_u32 v13, v7, 10, v15
    s_add_u32 s45, s44, 4
    v_mad_u32_u24 v7, v6, 5, s45
    v_and_b32 v15, 7, v7
    v_xor_b32 v15, v15, v5
    v_lshl_add_u32 v15, v15, 3, v4
    v_lshrrev_b32 v7, 3, v7
    v_lshl_add_u32 v14, v7, 10, v15
    s_cmp_ge_u32 s27, 4
    s_mov_b32 s44, 81920
    s_cmov_b32 s44, 163840
    s_mov_b32 s45, 1280
    s_cmov_b32 s45, 2560
    s_mov_b32 s46, 1051011932
    s_cmov_b32 s46, 1065353216
    s_mov_b32 s47, 5242880
    s_cmov_b32 s47, 0
    s_mov_b32 s48, 2621440
    s_cmov_b32 s48, 5242880
    s_add_u32 s28, s16, s47
    s_addc_u32 s29, s17, 0
    s_mov_b32 s30, s48
    s_mov_b32 s31, 0x00020000
    s_mul_i32 s47, s43, s44
    s_mul_i32 s48, s42, s45
    s_add_u32 s47, s47, s48
    v_lshlrev_b32 v16, 4, v1
    v_add_u32 v17, s45, v16
    v_lshrrev_b32 v4, 5, v1
    v_mul_lo_u32 v4, v4, s44
    v_and_b32 v5, 31, v1
    v_lshlrev_b32 v5, 3, v5
    v_lshl_add_u32 v4, v4, 1, v5
    v_add_u32 v18, 1024, v4
    v_add_u32 v19, s45, v18
    s_mov_b32 s48, s47
    s_add_u32 s49, s47, s44
    v_mov_b32 v96, 0
    v_mov_b32 v97, 0
    v_mov_b32 v98, 0
    v_mov_b32 v99, 0
    v_mov_b32 v100, 0
    v_mov_b32 v101, 0
    v_mov_b32 v102, 0
    v_mov_b32 v103, 0
    v_mov_b32 v104, 0
    v_mov_b32 v105, 0
    v_mov_b32 v106, 0
    v_mov_b32 v107, 0
    v_mov_b32 v108, 0
    v_mov_b32 v109, 0
    v_mov_b32 v110, 0
    v_mov_b32 v111, 0
    v_mov_b32 v112, 0
    v_mov_b32 v113, 0
    v_mov_b32 v114, 0
    v_mov_b32 v115, 0
    v_mov_b32 v116, 0
    v_mov_b32 v117, 0
    v_mov_b32 v118, 0
    v_mov_b32 v119, 0
    v_mov_b32 v120, 0
    v_mov_b32 v121, 0
    v_mov_b32 v122, 0
    v_mov_b32 v123, 0
    v_mov_b32 v124, 0
    v_mov_b32 v125, 0
    v_mov_b32 v126, 0
    v_mov_b32 v127, 0
    v_mov_b32 v128, 0
    v_mov_b32 v129, 0
    v_mov_b32 v130, 0
    v_mov_b32 v131, 0
    v_mov_b32 v132, 0
    v_mov_b32 v133, 0
    v_mov_b32 v134, 0
    v_mov_b32 v135, 0
    v_mov_b32 v136, 0
    v_mov_b32 v137, 0
    v_mov_b32 v138, 0
    v_mov_b32 v139, 0
    v_mov_b32 v140, 0
    v_mov_b32 v141, 0
    v_mov_b32 v142, 0
    v_mov_b32 v143, 0
    v_mov_b32 v144, 0
    v_mov_b32 v145, 0
    v_mov_b32 v146, 0
    v_mov_b32 v147, 0
    v_mov_b32 v148, 0
    v_mov_b32 v149, 0
    v_mov_b32 v150, 0
    v_mov_b32 v151, 0
    v_mov_b32 v152, 0
    v_mov_b32 v153, 0
    v_mov_b32 v154, 0
    v_mov_b32 v155, 0
    v_mov_b32 v156, 0
    v_mov_b32 v157, 0
    v_mov_b32 v158, 0
    v_mov_b32 v159, 0
    v_mov_b32 v160, 0
    v_mov_b32 v161, 0
    v_mov_b32 v162, 0
    v_mov_b32 v163, 0
    v_mov_b32 v164, 0
    v_mov_b32 v165, 0
    v_mov_b32 v166, 0
    v_mov_b32 v167, 0
    v_mov_b32 v168, 0
    v_mov_b32 v169, 0
    v_mov_b32 v170, 0
    v_mov_b32 v171, 0
    v_mov_b32 v172, 0
    v_mov_b32 v173, 0
    v_mov_b32 v174, 0
    v_mov_b32 v175, 0
    s_mov_b32 s40, 73728
    s_mov_b32 s41, 4
    s_barrier
    ds_read_b64_tr_b16 v[40:41], v10 offset:0
    ds_read_b64_tr_b16 v[42:43], v10 offset:256
    ds_read_b128 v[24:27], v8 offset:0
    ds_read_b128 v[28:31], v8 offset:2048
    ds_read_b128 v[32:35], v8 offset:4096
    ds_read_b128 v[36:39], v8 offset:6144
    ds_read_b64_tr_b16 v[44:45], v11 offset:0
    ds_read_b64_tr_b16 v[46:47], v11 offset:256
    ds_read_b64_tr_b16 v[48:49], v12 offset:0
    ds_read_b64_tr_b16 v[50:51], v12 offset:256
    ds_read_b64_tr_b16 v[52:53], v13 offset:0
    ds_read_b64_tr_b16 v[54:55], v13 offset:256
    ds_read_b64_tr_b16 v[56:57], v14 offset:0
    ds_read_b64_tr_b16 v[58:59], v14 offset:256
.p2align 3
L_gemm_3:
    s_waitcnt lgkmcnt(0)
    v_mfma_f32_16x16x32_bf16 v[96:99], v[40:43], v[24:27], v[96:99]
    ds_read_b64_tr_b16 v[76:77], v10 offset:10240
    v_mfma_f32_16x16x32_bf16 v[100:103], v[40:43], v[28:31], v[100:103]
    ds_read_b64_tr_b16 v[78:79], v10 offset:10496
    v_mfma_f32_16x16x32_bf16 v[104:107], v[40:43], v[32:35], v[104:107]
    ds_read_b128 v[60:63], v9 offset:0
    v_mfma_f32_16x16x32_bf16 v[108:111], v[40:43], v[36:39], v[108:111]
    ds_read_b128 v[64:67], v9 offset:2048
    v_mfma_f32_16x16x32_bf16 v[112:115], v[44:47], v[24:27], v[112:115]
    ds_read_b128 v[68:71], v9 offset:4096
    v_mfma_f32_16x16x32_bf16 v[116:119], v[44:47], v[28:31], v[116:119]
    ds_read_b128 v[72:75], v9 offset:6144
    v_mfma_f32_16x16x32_bf16 v[120:123], v[44:47], v[32:35], v[120:123]
    ds_read_b64_tr_b16 v[80:81], v11 offset:10240
    v_mfma_f32_16x16x32_bf16 v[124:127], v[44:47], v[36:39], v[124:127]
    ds_read_b64_tr_b16 v[82:83], v11 offset:10496
    v_mfma_f32_16x16x32_bf16 v[128:131], v[48:51], v[24:27], v[128:131]
    ds_read_b64_tr_b16 v[84:85], v12 offset:10240
    v_mfma_f32_16x16x32_bf16 v[132:135], v[48:51], v[28:31], v[132:135]
    ds_read_b64_tr_b16 v[86:87], v12 offset:10496
    v_mfma_f32_16x16x32_bf16 v[136:139], v[48:51], v[32:35], v[136:139]
    ds_read_b64_tr_b16 v[88:89], v13 offset:10240
    v_mfma_f32_16x16x32_bf16 v[140:143], v[48:51], v[36:39], v[140:143]
    ds_read_b64_tr_b16 v[90:91], v13 offset:10496
    v_mfma_f32_16x16x32_bf16 v[144:147], v[52:55], v[24:27], v[144:147]
    ds_read_b64_tr_b16 v[92:93], v14 offset:10240
    v_mfma_f32_16x16x32_bf16 v[148:151], v[52:55], v[28:31], v[148:151]
    ds_read_b64_tr_b16 v[94:95], v14 offset:10496
    v_mfma_f32_16x16x32_bf16 v[152:155], v[52:55], v[32:35], v[152:155]
    v_mfma_f32_16x16x32_bf16 v[156:159], v[52:55], v[36:39], v[156:159]
    v_mfma_f32_16x16x32_bf16 v[160:163], v[56:59], v[24:27], v[160:163]
    v_mfma_f32_16x16x32_bf16 v[164:167], v[56:59], v[28:31], v[164:167]
    v_mfma_f32_16x16x32_bf16 v[168:171], v[56:59], v[32:35], v[168:171]
    v_mfma_f32_16x16x32_bf16 v[172:175], v[56:59], v[36:39], v[172:175]
    s_waitcnt lgkmcnt(0)
    v_mfma_f32_16x16x32_bf16 v[96:99], v[76:79], v[60:63], v[96:99]
    s_barrier
    ds_read_b64_tr_b16 v[40:41], v10 offset:36864
    v_mfma_f32_16x16x32_bf16 v[100:103], v[76:79], v[64:67], v[100:103]
    ds_read_b64_tr_b16 v[42:43], v10 offset:37120
    v_mfma_f32_16x16x32_bf16 v[104:107], v[76:79], v[68:71], v[104:107]
    ds_read_b128 v[24:27], v8 offset:36864
    v_mfma_f32_16x16x32_bf16 v[108:111], v[76:79], v[72:75], v[108:111]
    ds_read_b128 v[28:31], v8 offset:38912
    v_mfma_f32_16x16x32_bf16 v[112:115], v[80:83], v[60:63], v[112:115]
    ds_read_b128 v[32:35], v8 offset:40960
    v_mfma_f32_16x16x32_bf16 v[116:119], v[80:83], v[64:67], v[116:119]
    ds_read_b128 v[36:39], v8 offset:43008
    v_mfma_f32_16x16x32_bf16 v[120:123], v[80:83], v[68:71], v[120:123]
    ds_read_b64_tr_b16 v[44:45], v11 offset:36864
    v_mfma_f32_16x16x32_bf16 v[124:127], v[80:83], v[72:75], v[124:127]
    ds_read_b64_tr_b16 v[46:47], v11 offset:37120
    v_mfma_f32_16x16x32_bf16 v[128:131], v[84:87], v[60:63], v[128:131]
    ds_read_b64_tr_b16 v[48:49], v12 offset:36864
    v_mfma_f32_16x16x32_bf16 v[132:135], v[84:87], v[64:67], v[132:135]
    ds_read_b64_tr_b16 v[50:51], v12 offset:37120
    v_mfma_f32_16x16x32_bf16 v[136:139], v[84:87], v[68:71], v[136:139]
    ds_read_b64_tr_b16 v[52:53], v13 offset:36864
    v_mfma_f32_16x16x32_bf16 v[140:143], v[84:87], v[72:75], v[140:143]
    ds_read_b64_tr_b16 v[54:55], v13 offset:37120
    v_mfma_f32_16x16x32_bf16 v[144:147], v[88:91], v[60:63], v[144:147]
    ds_read_b64_tr_b16 v[56:57], v14 offset:36864
    v_mfma_f32_16x16x32_bf16 v[148:151], v[88:91], v[64:67], v[148:151]
    ds_read_b64_tr_b16 v[58:59], v14 offset:37120
    v_mfma_f32_16x16x32_bf16 v[152:155], v[88:91], v[68:71], v[152:155]
    v_mfma_f32_16x16x32_bf16 v[156:159], v[88:91], v[72:75], v[156:159]
    v_mfma_f32_16x16x32_bf16 v[160:163], v[92:95], v[60:63], v[160:163]
    v_mfma_f32_16x16x32_bf16 v[164:167], v[92:95], v[64:67], v[164:167]
    v_mfma_f32_16x16x32_bf16 v[168:171], v[92:95], v[68:71], v[168:171]
    v_mfma_f32_16x16x32_bf16 v[172:175], v[92:95], v[72:75], v[172:175]
    s_waitcnt lgkmcnt(0)
    v_mfma_f32_16x16x32_bf16 v[96:99], v[40:43], v[24:27], v[96:99]
    ds_read_b64_tr_b16 v[76:77], v10 offset:47104
    v_mfma_f32_16x16x32_bf16 v[100:103], v[40:43], v[28:31], v[100:103]
    ds_read_b64_tr_b16 v[78:79], v10 offset:47360
    v_mfma_f32_16x16x32_bf16 v[104:107], v[40:43], v[32:35], v[104:107]
    ds_read_b128 v[60:63], v9 offset:36864
    v_mfma_f32_16x16x32_bf16 v[108:111], v[40:43], v[36:39], v[108:111]
    ds_read_b128 v[64:67], v9 offset:38912
    v_mfma_f32_16x16x32_bf16 v[112:115], v[44:47], v[24:27], v[112:115]
    ds_read_b128 v[68:71], v9 offset:40960
    v_mfma_f32_16x16x32_bf16 v[116:119], v[44:47], v[28:31], v[116:119]
    ds_read_b128 v[72:75], v9 offset:43008
    v_mfma_f32_16x16x32_bf16 v[120:123], v[44:47], v[32:35], v[120:123]
    ds_read_b64_tr_b16 v[80:81], v11 offset:47104
    v_mfma_f32_16x16x32_bf16 v[124:127], v[44:47], v[36:39], v[124:127]
    ds_read_b64_tr_b16 v[82:83], v11 offset:47360
    v_mfma_f32_16x16x32_bf16 v[128:131], v[48:51], v[24:27], v[128:131]
    ds_read_b64_tr_b16 v[84:85], v12 offset:47104
    v_mfma_f32_16x16x32_bf16 v[132:135], v[48:51], v[28:31], v[132:135]
    ds_read_b64_tr_b16 v[86:87], v12 offset:47360
    v_mfma_f32_16x16x32_bf16 v[136:139], v[48:51], v[32:35], v[136:139]
    ds_read_b64_tr_b16 v[88:89], v13 offset:47104
    v_mfma_f32_16x16x32_bf16 v[140:143], v[48:51], v[36:39], v[140:143]
    ds_read_b64_tr_b16 v[90:91], v13 offset:47360
    v_mfma_f32_16x16x32_bf16 v[144:147], v[52:55], v[24:27], v[144:147]
    ds_read_b64_tr_b16 v[92:93], v14 offset:47104
    v_mfma_f32_16x16x32_bf16 v[148:151], v[52:55], v[28:31], v[148:151]
    ds_read_b64_tr_b16 v[94:95], v14 offset:47360
    v_mfma_f32_16x16x32_bf16 v[152:155], v[52:55], v[32:35], v[152:155]
    v_mfma_f32_16x16x32_bf16 v[156:159], v[52:55], v[36:39], v[156:159]
    v_mfma_f32_16x16x32_bf16 v[160:163], v[56:59], v[24:27], v[160:163]
    v_mfma_f32_16x16x32_bf16 v[164:167], v[56:59], v[28:31], v[164:167]
    v_mfma_f32_16x16x32_bf16 v[168:171], v[56:59], v[32:35], v[168:171]
    v_mfma_f32_16x16x32_bf16 v[172:175], v[56:59], v[36:39], v[172:175]
    s_waitcnt lgkmcnt(0)
    v_mfma_f32_16x16x32_bf16 v[96:99], v[76:79], v[60:63], v[96:99]
    v_add_u32 v8, s40, v8
    v_add_u32 v9, s40, v9
    v_add_u32 v10, s40, v10
    v_add_u32 v11, s40, v11
    v_add_u32 v12, s40, v12
    v_add_u32 v13, s40, v13
    v_add_u32 v14, s40, v14
    s_sub_u32 s40, 0, s40
    s_sub_u32 s41, s41, 1
    s_barrier
    s_cmp_eq_u32 s41, 0
    s_cbranch_scc1 L_gemm_last_4
    ds_read_b64_tr_b16 v[40:41], v10 offset:0
    v_mfma_f32_16x16x32_bf16 v[100:103], v[76:79], v[64:67], v[100:103]
    ds_read_b64_tr_b16 v[42:43], v10 offset:256
    v_mfma_f32_16x16x32_bf16 v[104:107], v[76:79], v[68:71], v[104:107]
    ds_read_b128 v[24:27], v8 offset:0
    v_mfma_f32_16x16x32_bf16 v[108:111], v[76:79], v[72:75], v[108:111]
    ds_read_b128 v[28:31], v8 offset:2048
    v_mfma_f32_16x16x32_bf16 v[112:115], v[80:83], v[60:63], v[112:115]
    ds_read_b128 v[32:35], v8 offset:4096
    v_mfma_f32_16x16x32_bf16 v[116:119], v[80:83], v[64:67], v[116:119]
    ds_read_b128 v[36:39], v8 offset:6144
    v_mfma_f32_16x16x32_bf16 v[120:123], v[80:83], v[68:71], v[120:123]
    ds_read_b64_tr_b16 v[44:45], v11 offset:0
    v_mfma_f32_16x16x32_bf16 v[124:127], v[80:83], v[72:75], v[124:127]
    ds_read_b64_tr_b16 v[46:47], v11 offset:256
    v_mfma_f32_16x16x32_bf16 v[128:131], v[84:87], v[60:63], v[128:131]
    ds_read_b64_tr_b16 v[48:49], v12 offset:0
    v_mfma_f32_16x16x32_bf16 v[132:135], v[84:87], v[64:67], v[132:135]
    ds_read_b64_tr_b16 v[50:51], v12 offset:256
    v_mfma_f32_16x16x32_bf16 v[136:139], v[84:87], v[68:71], v[136:139]
    ds_read_b64_tr_b16 v[52:53], v13 offset:0
    v_mfma_f32_16x16x32_bf16 v[140:143], v[84:87], v[72:75], v[140:143]
    ds_read_b64_tr_b16 v[54:55], v13 offset:256
    v_mfma_f32_16x16x32_bf16 v[144:147], v[88:91], v[60:63], v[144:147]
    ds_read_b64_tr_b16 v[56:57], v14 offset:0
    v_mfma_f32_16x16x32_bf16 v[148:151], v[88:91], v[64:67], v[148:151]
    ds_read_b64_tr_b16 v[58:59], v14 offset:256
    v_mfma_f32_16x16x32_bf16 v[152:155], v[88:91], v[68:71], v[152:155]
    v_mfma_f32_16x16x32_bf16 v[156:159], v[88:91], v[72:75], v[156:159]
    v_mfma_f32_16x16x32_bf16 v[160:163], v[92:95], v[60:63], v[160:163]
    v_mfma_f32_16x16x32_bf16 v[164:167], v[92:95], v[64:67], v[164:167]
    v_mfma_f32_16x16x32_bf16 v[168:171], v[92:95], v[68:71], v[168:171]
    v_mfma_f32_16x16x32_bf16 v[172:175], v[92:95], v[72:75], v[172:175]
    s_branch L_gemm_3
L_gemm_last_4:
    ds_read_b64_tr_b16 v[40:41], v10 offset:0
    ds_read_b64_tr_b16 v[42:43], v10 offset:256
    v_mfma_f32_16x16x32_bf16 v[100:103], v[76:79], v[64:67], v[100:103]
    ds_read_b128 v[24:27], v8 offset:0
    ds_read_b128 v[28:31], v8 offset:2048
    v_mfma_f32_16x16x32_bf16 v[104:107], v[76:79], v[68:71], v[104:107]
    ds_read_b128 v[32:35], v8 offset:4096
    ds_read_b128 v[36:39], v8 offset:6144
    v_mfma_f32_16x16x32_bf16 v[108:111], v[76:79], v[72:75], v[108:111]
    ds_read_b64_tr_b16 v[192:193], v10 offset:10240
    ds_read_b64_tr_b16 v[194:195], v10 offset:10496
    v_mfma_f32_16x16x32_bf16 v[112:115], v[80:83], v[60:63], v[112:115]
    ds_read_b128 v[176:179], v9 offset:0
    ds_read_b128 v[180:183], v9 offset:2048
    v_mfma_f32_16x16x32_bf16 v[116:119], v[80:83], v[64:67], v[116:119]
    ds_read_b128 v[184:187], v9 offset:4096
    ds_read_b128 v[188:191], v9 offset:6144
    v_mfma_f32_16x16x32_bf16 v[120:123], v[80:83], v[68:71], v[120:123]
    ds_read_b64_tr_b16 v[44:45], v11 offset:0
    ds_read_b64_tr_b16 v[46:47], v11 offset:256
    v_mfma_f32_16x16x32_bf16 v[124:127], v[80:83], v[72:75], v[124:127]
    ds_read_b64_tr_b16 v[196:197], v11 offset:10240
    ds_read_b64_tr_b16 v[198:199], v11 offset:10496
    v_mfma_f32_16x16x32_bf16 v[128:131], v[84:87], v[60:63], v[128:131]
    ds_read_b64_tr_b16 v[48:49], v12 offset:0
    ds_read_b64_tr_b16 v[50:51], v12 offset:256
    v_mfma_f32_16x16x32_bf16 v[132:135], v[84:87], v[64:67], v[132:135]
    ds_read_b64_tr_b16 v[200:201], v12 offset:10240
    v_mfma_f32_16x16x32_bf16 v[136:139], v[84:87], v[68:71], v[136:139]
    ds_read_b64_tr_b16 v[202:203], v12 offset:10496
    v_mfma_f32_16x16x32_bf16 v[140:143], v[84:87], v[72:75], v[140:143]
    ds_read_b64_tr_b16 v[52:53], v13 offset:0
    v_mfma_f32_16x16x32_bf16 v[144:147], v[88:91], v[60:63], v[144:147]
    ds_read_b64_tr_b16 v[54:55], v13 offset:256
    v_mfma_f32_16x16x32_bf16 v[148:151], v[88:91], v[64:67], v[148:151]
    ds_read_b64_tr_b16 v[204:205], v13 offset:10240
    v_mfma_f32_16x16x32_bf16 v[152:155], v[88:91], v[68:71], v[152:155]
    ds_read_b64_tr_b16 v[206:207], v13 offset:10496
    v_mfma_f32_16x16x32_bf16 v[156:159], v[88:91], v[72:75], v[156:159]
    ds_read_b64_tr_b16 v[56:57], v14 offset:0
    v_mfma_f32_16x16x32_bf16 v[160:163], v[92:95], v[60:63], v[160:163]
    ds_read_b64_tr_b16 v[58:59], v14 offset:256
    v_mfma_f32_16x16x32_bf16 v[164:167], v[92:95], v[64:67], v[164:167]
    ds_read_b64_tr_b16 v[208:209], v14 offset:10240
    v_mfma_f32_16x16x32_bf16 v[168:171], v[92:95], v[68:71], v[168:171]
    ds_read_b64_tr_b16 v[210:211], v14 offset:10496
    v_mfma_f32_16x16x32_bf16 v[172:175], v[92:95], v[72:75], v[172:175]
    s_barrier
    s_waitcnt lgkmcnt(0)
    v_mfma_f32_16x16x32_bf16 v[96:99], v[40:43], v[24:27], v[96:99]
    ds_read_b64_tr_b16 v[228:229], v10 offset:36864
    ds_read_b64_tr_b16 v[230:231], v10 offset:37120
    v_mfma_f32_16x16x32_bf16 v[100:103], v[40:43], v[28:31], v[100:103]
    ds_read_b128 v[212:215], v8 offset:36864
    ds_read_b128 v[216:219], v8 offset:38912
    v_mfma_f32_16x16x32_bf16 v[104:107], v[40:43], v[32:35], v[104:107]
    ds_read_b128 v[220:223], v8 offset:40960
    ds_read_b128 v[224:227], v8 offset:43008
    v_mfma_f32_16x16x32_bf16 v[108:111], v[40:43], v[36:39], v[108:111]
    ds_read_b64_tr_b16 v[76:77], v10 offset:47104
    ds_read_b64_tr_b16 v[78:79], v10 offset:47360
    v_mfma_f32_16x16x32_bf16 v[96:99], v[192:195], v[176:179], v[96:99]
    ds_read_b128 v[60:63], v9 offset:36864
    ds_read_b128 v[64:67], v9 offset:38912
    v_mfma_f32_16x16x32_bf16 v[100:103], v[192:195], v[180:183], v[100:103]
    ds_read_b128 v[68:71], v9 offset:40960
    ds_read_b128 v[72:75], v9 offset:43008
    v_mfma_f32_16x16x32_bf16 v[104:107], v[192:195], v[184:187], v[104:107]
    ds_read_b64_tr_b16 v[232:233], v11 offset:36864
    ds_read_b64_tr_b16 v[234:235], v11 offset:37120
    v_mfma_f32_16x16x32_bf16 v[108:111], v[192:195], v[188:191], v[108:111]
    ds_read_b64_tr_b16 v[80:81], v11 offset:47104
    ds_read_b64_tr_b16 v[82:83], v11 offset:47360
    s_waitcnt lgkmcnt(4)
    v_mfma_f32_16x16x32_bf16 v[96:99], v[228:231], v[212:215], v[96:99]
    ds_read_b64_tr_b16 v[236:237], v12 offset:36864
    ds_read_b64_tr_b16 v[238:239], v12 offset:37120
    v_mfma_f32_16x16x32_bf16 v[100:103], v[228:231], v[216:219], v[100:103]
    ds_read_b64_tr_b16 v[84:85], v12 offset:47104
    ds_read_b64_tr_b16 v[86:87], v12 offset:47360
    v_mfma_f32_16x16x32_bf16 v[104:107], v[228:231], v[220:223], v[104:107]
    ds_read_b64_tr_b16 v[240:241], v13 offset:36864
    ds_read_b64_tr_b16 v[242:243], v13 offset:37120
    v_mfma_f32_16x16x32_bf16 v[108:111], v[228:231], v[224:227], v[108:111]
    ds_read_b64_tr_b16 v[88:89], v13 offset:47104
    ds_read_b64_tr_b16 v[90:91], v13 offset:47360
    v_mfma_f32_16x16x32_bf16 v[96:99], v[76:79], v[60:63], v[96:99]
    ds_read_b64_tr_b16 v[244:245], v14 offset:36864
    ds_read_b64_tr_b16 v[246:247], v14 offset:37120
    v_mfma_f32_16x16x32_bf16 v[100:103], v[76:79], v[64:67], v[100:103]
    ds_read_b64_tr_b16 v[92:93], v14 offset:47104
    ds_read_b64_tr_b16 v[94:95], v14 offset:47360
    v_mfma_f32_16x16x32_bf16 v[104:107], v[76:79], v[68:71], v[104:107]
    v_mfma_f32_16x16x32_bf16 v[108:111], v[76:79], v[72:75], v[108:111]
    v_mfma_f32_16x16x32_bf16 v[112:115], v[44:47], v[24:27], v[112:115]
    v_mfma_f32_16x16x32_bf16 v[116:119], v[44:47], v[28:31], v[116:119]
    v_mfma_f32_16x16x32_bf16 v[120:123], v[44:47], v[32:35], v[120:123]
    v_mfma_f32_16x16x32_bf16 v[124:127], v[44:47], v[36:39], v[124:127]
    v_mfma_f32_16x16x32_bf16 v[112:115], v[196:199], v[176:179], v[112:115]
    v_mul_f32 v96, s46, v96
    v_mul_f32 v97, s46, v97
    v_mul_f32 v98, s46, v98
    v_mfma_f32_16x16x32_bf16 v[116:119], v[196:199], v[180:183], v[116:119]
    v_mul_f32 v99, s46, v99
    v_mul_f32 v100, s46, v100
    v_mul_f32 v101, s46, v101
    v_mfma_f32_16x16x32_bf16 v[120:123], v[196:199], v[184:187], v[120:123]
    v_mul_f32 v102, s46, v102
    v_mul_f32 v103, s46, v103
    v_mul_f32 v104, s46, v104
    v_mfma_f32_16x16x32_bf16 v[124:127], v[196:199], v[188:191], v[124:127]
    v_mul_f32 v105, s46, v105
    v_mul_f32 v106, s46, v106
    v_mul_f32 v107, s46, v107
    s_waitcnt lgkmcnt(0)
    v_mfma_f32_16x16x32_bf16 v[112:115], v[232:235], v[212:215], v[112:115]
    v_mul_f32 v108, s46, v108
    v_mul_f32 v109, s46, v109
    v_mul_f32 v110, s46, v110
    v_mfma_f32_16x16x32_bf16 v[116:119], v[232:235], v[216:219], v[116:119]
    v_mul_f32 v111, s46, v111
    v_cvt_pk_bf16_f32 v96, v96, v97
    v_cvt_pk_bf16_f32 v97, v98, v99
    v_mfma_f32_16x16x32_bf16 v[120:123], v[232:235], v[220:223], v[120:123]
    v_cvt_pk_bf16_f32 v98, v100, v101
    v_cvt_pk_bf16_f32 v99, v102, v103
    v_cvt_pk_bf16_f32 v100, v104, v105
    v_mfma_f32_16x16x32_bf16 v[124:127], v[232:235], v[224:227], v[124:127]
    v_cvt_pk_bf16_f32 v101, v106, v107
    v_cvt_pk_bf16_f32 v102, v108, v109
    v_cvt_pk_bf16_f32 v103, v110, v111
    v_mfma_f32_16x16x32_bf16 v[112:115], v[80:83], v[60:63], v[112:115]
    s_nop 0
    v_permlane16_swap_b32 v96, v98
    v_permlane16_swap_b32 v97, v99
    v_mfma_f32_16x16x32_bf16 v[116:119], v[80:83], v[64:67], v[116:119]
    v_permlane16_swap_b32 v100, v102
    v_permlane16_swap_b32 v101, v103
    buffer_store_dwordx4 v[96:99], v16, s[28:31], s48 offen sc1
    v_mfma_f32_16x16x32_bf16 v[120:123], v[80:83], v[68:71], v[120:123]
    buffer_store_dwordx4 v[100:103], v17, s[28:31], s48 offen sc1
    s_add_u32 s48, s48, s44
    v_mfma_f32_16x16x32_bf16 v[124:127], v[80:83], v[72:75], v[124:127]
    v_mfma_f32_16x16x32_bf16 v[128:131], v[48:51], v[24:27], v[128:131]
    v_mfma_f32_16x16x32_bf16 v[132:135], v[48:51], v[28:31], v[132:135]
    v_mfma_f32_16x16x32_bf16 v[136:139], v[48:51], v[32:35], v[136:139]
    v_mfma_f32_16x16x32_bf16 v[140:143], v[48:51], v[36:39], v[140:143]
    v_mfma_f32_16x16x32_bf16 v[128:131], v[200:203], v[176:179], v[128:131]
    v_mul_f32 v112, s46, v112
    v_mul_f32 v113, s46, v113
    v_mul_f32 v114, s46, v114
    v_mfma_f32_16x16x32_bf16 v[132:135], v[200:203], v[180:183], v[132:135]
    v_mul_f32 v115, s46, v115
    v_mul_f32 v116, s46, v116
    v_mul_f32 v117, s46, v117
    v_mfma_f32_16x16x32_bf16 v[136:139], v[200:203], v[184:187], v[136:139]
    v_mul_f32 v118, s46, v118
    v_mul_f32 v119, s46, v119
    v_mul_f32 v120, s46, v120
    v_mfma_f32_16x16x32_bf16 v[140:143], v[200:203], v[188:191], v[140:143]
    v_mul_f32 v121, s46, v121
    v_mul_f32 v122, s46, v122
    v_mul_f32 v123, s46, v123
    v_mfma_f32_16x16x32_bf16 v[128:131], v[236:239], v[212:215], v[128:131]
    v_mul_f32 v124, s46, v124
    v_mul_f32 v125, s46, v125
    v_mul_f32 v126, s46, v126
    v_mfma_f32_16x16x32_bf16 v[132:135], v[236:239], v[216:219], v[132:135]
    v_mul_f32 v127, s46, v127
    v_cvt_pk_bf16_f32 v112, v112, v113
    v_cvt_pk_bf16_f32 v113, v114, v115
    v_mfma_f32_16x16x32_bf16 v[136:139], v[236:239], v[220:223], v[136:139]
    v_cvt_pk_bf16_f32 v114, v116, v117
    v_cvt_pk_bf16_f32 v115, v118, v119
    v_cvt_pk_bf16_f32 v116, v120, v121
    v_mfma_f32_16x16x32_bf16 v[140:143], v[236:239], v[224:227], v[140:143]
    v_cvt_pk_bf16_f32 v117, v122, v123
    v_cvt_pk_bf16_f32 v118, v124, v125
    v_cvt_pk_bf16_f32 v119, v126, v127
    v_mfma_f32_16x16x32_bf16 v[128:131], v[84:87], v[60:63], v[128:131]
    s_nop 0
    v_permlane16_swap_b32 v112, v114
    v_permlane16_swap_b32 v113, v115
    v_mfma_f32_16x16x32_bf16 v[132:135], v[84:87], v[64:67], v[132:135]
    v_permlane16_swap_b32 v116, v118
    v_permlane16_swap_b32 v117, v119
    buffer_store_dwordx4 v[112:115], v16, s[28:31], s48 offen sc1
    v_mfma_f32_16x16x32_bf16 v[136:139], v[84:87], v[68:71], v[136:139]
    buffer_store_dwordx4 v[116:119], v17, s[28:31], s48 offen sc1
    s_add_u32 s48, s48, s44
    v_mfma_f32_16x16x32_bf16 v[140:143], v[84:87], v[72:75], v[140:143]
    v_mfma_f32_16x16x32_bf16 v[144:147], v[52:55], v[24:27], v[144:147]
    v_mfma_f32_16x16x32_bf16 v[148:151], v[52:55], v[28:31], v[148:151]
    v_mfma_f32_16x16x32_bf16 v[152:155], v[52:55], v[32:35], v[152:155]
    v_mfma_f32_16x16x32_bf16 v[156:159], v[52:55], v[36:39], v[156:159]
    v_mfma_f32_16x16x32_bf16 v[144:147], v[204:207], v[176:179], v[144:147]
    v_mul_f32 v128, s46, v128
    v_mul_f32 v129, s46, v129
    v_mul_f32 v130, s46, v130
    v_mfma_f32_16x16x32_bf16 v[148:151], v[204:207], v[180:183], v[148:151]
    v_mul_f32 v131, s46, v131
    v_mul_f32 v132, s46, v132
    v_mul_f32 v133, s46, v133
    v_mfma_f32_16x16x32_bf16 v[152:155], v[204:207], v[184:187], v[152:155]
    v_mul_f32 v134, s46, v134
    v_mul_f32 v135, s46, v135
    v_mul_f32 v136, s46, v136
    v_mfma_f32_16x16x32_bf16 v[156:159], v[204:207], v[188:191], v[156:159]
    v_mul_f32 v137, s46, v137
    v_mul_f32 v138, s46, v138
    v_mul_f32 v139, s46, v139
    v_mfma_f32_16x16x32_bf16 v[144:147], v[240:243], v[212:215], v[144:147]
    v_mul_f32 v140, s46, v140
    v_mul_f32 v141, s46, v141
    v_mul_f32 v142, s46, v142
    v_mfma_f32_16x16x32_bf16 v[148:151], v[240:243], v[216:219], v[148:151]
    v_mul_f32 v143, s46, v143
    v_cvt_pk_bf16_f32 v128, v128, v129
    v_cvt_pk_bf16_f32 v129, v130, v131
    v_mfma_f32_16x16x32_bf16 v[152:155], v[240:243], v[220:223], v[152:155]
    v_cvt_pk_bf16_f32 v130, v132, v133
    v_cvt_pk_bf16_f32 v131, v134, v135
    v_cvt_pk_bf16_f32 v132, v136, v137
    v_mfma_f32_16x16x32_bf16 v[156:159], v[240:243], v[224:227], v[156:159]
    v_cvt_pk_bf16_f32 v133, v138, v139
    v_cvt_pk_bf16_f32 v134, v140, v141
    v_cvt_pk_bf16_f32 v135, v142, v143
    v_mfma_f32_16x16x32_bf16 v[144:147], v[88:91], v[60:63], v[144:147]
    s_nop 0
    v_permlane16_swap_b32 v128, v130
    v_permlane16_swap_b32 v129, v131
    v_mfma_f32_16x16x32_bf16 v[148:151], v[88:91], v[64:67], v[148:151]
    v_permlane16_swap_b32 v132, v134
    v_permlane16_swap_b32 v133, v135
    buffer_store_dwordx4 v[128:131], v16, s[28:31], s48 offen sc1
    v_mfma_f32_16x16x32_bf16 v[152:155], v[88:91], v[68:71], v[152:155]
    buffer_store_dwordx4 v[132:135], v17, s[28:31], s48 offen sc1
    s_add_u32 s48, s48, s44
    v_mfma_f32_16x16x32_bf16 v[156:159], v[88:91], v[72:75], v[156:159]
    v_mfma_f32_16x16x32_bf16 v[160:163], v[56:59], v[24:27], v[160:163]
    v_mfma_f32_16x16x32_bf16 v[164:167], v[56:59], v[28:31], v[164:167]
    v_mfma_f32_16x16x32_bf16 v[168:171], v[56:59], v[32:35], v[168:171]
    v_mfma_f32_16x16x32_bf16 v[172:175], v[56:59], v[36:39], v[172:175]
    v_mfma_f32_16x16x32_bf16 v[160:163], v[208:211], v[176:179], v[160:163]
    v_mul_f32 v144, s46, v144
    v_mul_f32 v145, s46, v145
    v_mul_f32 v146, s46, v146
    v_mfma_f32_16x16x32_bf16 v[164:167], v[208:211], v[180:183], v[164:167]
    v_mul_f32 v147, s46, v147
    v_mul_f32 v148, s46, v148
    v_mul_f32 v149, s46, v149
    v_mfma_f32_16x16x32_bf16 v[168:171], v[208:211], v[184:187], v[168:171]
    v_mul_f32 v150, s46, v150
    v_mul_f32 v151, s46, v151
    v_mul_f32 v152, s46, v152
    v_mfma_f32_16x16x32_bf16 v[172:175], v[208:211], v[188:191], v[172:175]
    v_mul_f32 v153, s46, v153
    v_mul_f32 v154, s46, v154
    v_mul_f32 v155, s46, v155
    v_mfma_f32_16x16x32_bf16 v[160:163], v[244:247], v[212:215], v[160:163]
    v_mul_f32 v156, s46, v156
    v_mul_f32 v157, s46, v157
    v_mul_f32 v158, s46, v158
    v_mfma_f32_16x16x32_bf16 v[164:167], v[244:247], v[216:219], v[164:167]
    v_mul_f32 v159, s46, v159
    v_cvt_pk_bf16_f32 v144, v144, v145
    v_cvt_pk_bf16_f32 v145, v146, v147
    v_mfma_f32_16x16x32_bf16 v[168:171], v[244:247], v[220:223], v[168:171]
    v_cvt_pk_bf16_f32 v146, v148, v149
    v_cvt_pk_bf16_f32 v147, v150, v151
    v_cvt_pk_bf16_f32 v148, v152, v153
    v_mfma_f32_16x16x32_bf16 v[172:175], v[244:247], v[224:227], v[172:175]
    v_cvt_pk_bf16_f32 v149, v154, v155
    v_cvt_pk_bf16_f32 v150, v156, v157
    v_cvt_pk_bf16_f32 v151, v158, v159
    v_mfma_f32_16x16x32_bf16 v[160:163], v[92:95], v[60:63], v[160:163]
    s_nop 0
    v_permlane16_swap_b32 v144, v146
    v_permlane16_swap_b32 v145, v147
    v_mfma_f32_16x16x32_bf16 v[164:167], v[92:95], v[64:67], v[164:167]
    v_permlane16_swap_b32 v148, v150
    v_permlane16_swap_b32 v149, v151
    buffer_store_dwordx4 v[144:147], v16, s[28:31], s48 offen sc1
    v_mfma_f32_16x16x32_bf16 v[168:171], v[92:95], v[68:71], v[168:171]
    buffer_store_dwordx4 v[148:151], v17, s[28:31], s48 offen sc1
    v_mfma_f32_16x16x32_bf16 v[172:175], v[92:95], v[72:75], v[172:175]
    s_nop 7
    v_mul_f32 v160, s46, v160
    v_mul_f32 v161, s46, v161
    v_mul_f32 v162, s46, v162
    v_mul_f32 v163, s46, v163
    v_mul_f32 v164, s46, v164
    v_mul_f32 v165, s46, v165
    v_mul_f32 v166, s46, v166
    v_mul_f32 v167, s46, v167
    v_mul_f32 v168, s46, v168
    v_mul_f32 v169, s46, v169
    v_mul_f32 v170, s46, v170
    v_mul_f32 v171, s46, v171
    v_mul_f32 v172, s46, v172
    v_mul_f32 v173, s46, v173
    v_mul_f32 v174, s46, v174
    v_mul_f32 v175, s46, v175
    v_cvt_pk_bf16_f32 v160, v160, v161
    v_cvt_pk_bf16_f32 v161, v162, v163
    v_cvt_pk_bf16_f32 v162, v164, v165
    v_cvt_pk_bf16_f32 v163, v166, v167
    v_cvt_pk_bf16_f32 v164, v168, v169
    v_cvt_pk_bf16_f32 v165, v170, v171
    v_cvt_pk_bf16_f32 v166, v172, v173
    v_cvt_pk_bf16_f32 v167, v174, v175
    s_nop 0
    v_permlane16_swap_b32 v160, v162
    v_permlane16_swap_b32 v161, v163
    v_permlane16_swap_b32 v164, v166
    v_permlane16_swap_b32 v165, v167
    buffer_store_dwordx2 v[160:161], v18, s[28:31], s47 offen sc1
    buffer_store_dwordx2 v[162:163], v18, s[28:31], s49 offen sc1
    buffer_store_dwordx2 v[164:165], v19, s[28:31], s47 offen sc1
    buffer_store_dwordx2 v[166:167], v19, s[28:31], s49 offen sc1
    s_branch L_A_done
L_compute_v:
    s_add_u32 s45, s44, 0
    v_add_u32 v7, s45, v6
    v_and_b32 v15, 7, v7
    v_xor_b32 v15, v15, v5
    v_lshl_add_u32 v15, v15, 3, v4
    v_lshrrev_b32 v7, 3, v7
    v_lshl_add_u32 v10, v7, 10, v15
    s_add_u32 s45, s44, 4
    v_add_u32 v7, s45, v6
    v_and_b32 v15, 7, v7
    v_xor_b32 v15, v15, v5
    v_lshl_add_u32 v15, v15, 3, v4
    v_lshrrev_b32 v7, 3, v7
    v_lshl_add_u32 v11, v7, 10, v15
    s_add_u32 s45, s44, 8
    v_add_u32 v7, s45, v6
    v_and_b32 v15, 7, v7
    v_xor_b32 v15, v15, v5
    v_lshl_add_u32 v15, v15, 3, v4
    v_lshrrev_b32 v7, 3, v7
    v_lshl_add_u32 v12, v7, 10, v15
    s_add_u32 s45, s44, 12
    v_add_u32 v7, s45, v6
    v_and_b32 v15, 7, v7
    v_xor_b32 v15, v15, v5
    v_lshl_add_u32 v15, v15, 3, v4
    v_lshrrev_b32 v7, 3, v7
    v_lshl_add_u32 v13, v7, 10, v15
    s_add_u32 s45, s44, 16
    v_add_u32 v7, s45, v6
    v_and_b32 v15, 7, v7
    v_xor_b32 v15, v15, v5
    v_lshl_add_u32 v15, v15, 3, v4
    v_lshrrev_b32 v7, 3, v7
    v_lshl_add_u32 v14, v7, 10, v15
    s_mov_b32 s28, s16
    s_mov_b32 s29, s17
    s_mov_b32 s30, 5242880
    s_mov_b32 s31, 0x00020000
    s_mov_b32 s44, 163840
    s_mul_i32 s47, s43, s44
    s_mul_i32 s48, s42, 2560
    s_add_u32 s47, s47, s48
    v_lshrrev_b32 v7, 5, v1
    v_mul_u32_u24 v7, 640, v7
    v_and_b32 v15, 1, v3
    v_lshl_add_u32 v7, v15, 6, v7
    v_add_u32 v7, 1280, v7
    v_add_u32 v4, 0, v2
    v_mul_u32_u24 v5, 3277, v4
    v_lshrrev_b32 v5, 16, v5
    v_mul_u32_u24 v6, 20, v5
    v_sub_u32 v4, v4, v6
    v_and_b32 v6, 28, v4
    v_add_u32 v4, v4, v6
    v_mul_lo_u32 v5, v5, s44
    v_lshl_add_u32 v4, v4, 4, v5
    v_add_u32 v16, v7, v4
    v_add_u32 v4, 16, v2
    v_mul_u32_u24 v5, 3277, v4
    v_lshrrev_b32 v5, 16, v5
    v_mul_u32_u24 v6, 20, v5
    v_sub_u32 v4, v4, v6
    v_and_b32 v6, 28, v4
    v_add_u32 v4, v4, v6
    v_mul_lo_u32 v5, v5, s44
    v_lshl_add_u32 v4, v4, 4, v5
    v_add_u32 v17, v7, v4
    v_add_u32 v4, 32, v2
    v_mul_u32_u24 v5, 3277, v4
    v_lshrrev_b32 v5, 16, v5
    v_mul_u32_u24 v6, 20, v5
    v_sub_u32 v4, v4, v6
    v_and_b32 v6, 28, v4
    v_add_u32 v4, v4, v6
    v_mul_lo_u32 v5, v5, s44
    v_lshl_add_u32 v4, v4, 4, v5
    v_add_u32 v18, v7, v4
    v_add_u32 v4, 48, v2
    v_mul_u32_u24 v5, 3277, v4
    v_lshrrev_b32 v5, 16, v5
    v_mul_u32_u24 v6, 20, v5
    v_sub_u32 v4, v4, v6
    v_and_b32 v6, 28, v4
    v_add_u32 v4, v4, v6
    v_mul_lo_u32 v5, v5, s44
    v_lshl_add_u32 v4, v4, 4, v5
    v_add_u32 v19, v7, v4
    v_add_u32 v4, 64, v2
    v_mul_u32_u24 v5, 3277, v4
    v_lshrrev_b32 v5, 16, v5
    v_mul_u32_u24 v6, 20, v5
    v_sub_u32 v4, v4, v6
    v_and_b32 v6, 28, v4
    v_add_u32 v4, v4, v6
    v_mul_lo_u32 v5, v5, s44
    v_lshl_add_u32 v4, v4, 4, v5
    v_add_u32 v20, v7, v4
    v_mov_b32 v96, 0
    v_mov_b32 v97, 0
    v_mov_b32 v98, 0
    v_mov_b32 v99, 0
    v_mov_b32 v100, 0
    v_mov_b32 v101, 0
    v_mov_b32 v102, 0
    v_mov_b32 v103, 0
    v_mov_b32 v104, 0
    v_mov_b32 v105, 0
    v_mov_b32 v106, 0
    v_mov_b32 v107, 0
    v_mov_b32 v108, 0
    v_mov_b32 v109, 0
    v_mov_b32 v110, 0
    v_mov_b32 v111, 0
    v_mov_b32 v112, 0
    v_mov_b32 v113, 0
    v_mov_b32 v114, 0
    v_mov_b32 v115, 0
    v_mov_b32 v116, 0
    v_mov_b32 v117, 0
    v_mov_b32 v118, 0
    v_mov_b32 v119, 0
    v_mov_b32 v120, 0
    v_mov_b32 v121, 0
    v_mov_b32 v122, 0
    v_mov_b32 v123, 0
    v_mov_b32 v124, 0
    v_mov_b32 v125, 0
    v_mov_b32 v126, 0
    v_mov_b32 v127, 0
    v_mov_b32 v128, 0
    v_mov_b32 v129, 0
    v_mov_b32 v130, 0
    v_mov_b32 v131, 0
    v_mov_b32 v132, 0
    v_mov_b32 v133, 0
    v_mov_b32 v134, 0
    v_mov_b32 v135, 0
    v_mov_b32 v136, 0
    v_mov_b32 v137, 0
    v_mov_b32 v138, 0
    v_mov_b32 v139, 0
    v_mov_b32 v140, 0
    v_mov_b32 v141, 0
    v_mov_b32 v142, 0
    v_mov_b32 v143, 0
    v_mov_b32 v144, 0
    v_mov_b32 v145, 0
    v_mov_b32 v146, 0
    v_mov_b32 v147, 0
    v_mov_b32 v148, 0
    v_mov_b32 v149, 0
    v_mov_b32 v150, 0
    v_mov_b32 v151, 0
    v_mov_b32 v152, 0
    v_mov_b32 v153, 0
    v_mov_b32 v154, 0
    v_mov_b32 v155, 0
    v_mov_b32 v156, 0
    v_mov_b32 v157, 0
    v_mov_b32 v158, 0
    v_mov_b32 v159, 0
    v_mov_b32 v160, 0
    v_mov_b32 v161, 0
    v_mov_b32 v162, 0
    v_mov_b32 v163, 0
    v_mov_b32 v164, 0
    v_mov_b32 v165, 0
    v_mov_b32 v166, 0
    v_mov_b32 v167, 0
    v_mov_b32 v168, 0
    v_mov_b32 v169, 0
    v_mov_b32 v170, 0
    v_mov_b32 v171, 0
    v_mov_b32 v172, 0
    v_mov_b32 v173, 0
    v_mov_b32 v174, 0
    v_mov_b32 v175, 0
    s_mov_b32 s40, 73728
    s_mov_b32 s41, 4
    s_barrier
    ds_read_b64_tr_b16 v[40:41], v10 offset:0
    ds_read_b64_tr_b16 v[42:43], v10 offset:256
    ds_read_b128 v[24:27], v8 offset:0
    ds_read_b128 v[28:31], v8 offset:2048
    ds_read_b128 v[32:35], v8 offset:4096
    ds_read_b128 v[36:39], v8 offset:6144
    ds_read_b64_tr_b16 v[44:45], v11 offset:0
    ds_read_b64_tr_b16 v[46:47], v11 offset:256
    ds_read_b64_tr_b16 v[48:49], v12 offset:0
    ds_read_b64_tr_b16 v[50:51], v12 offset:256
    ds_read_b64_tr_b16 v[52:53], v13 offset:0
    ds_read_b64_tr_b16 v[54:55], v13 offset:256
    ds_read_b64_tr_b16 v[56:57], v14 offset:0
    ds_read_b64_tr_b16 v[58:59], v14 offset:256
.p2align 3
L_gemm_5:
    s_waitcnt lgkmcnt(0)
    v_mfma_f32_16x16x32_bf16 v[96:99], v[24:27], v[40:43], v[96:99]
    ds_read_b64_tr_b16 v[76:77], v10 offset:10240
    v_mfma_f32_16x16x32_bf16 v[100:103], v[28:31], v[40:43], v[100:103]
    ds_read_b64_tr_b16 v[78:79], v10 offset:10496
    v_mfma_f32_16x16x32_bf16 v[104:107], v[32:35], v[40:43], v[104:107]
    ds_read_b128 v[60:63], v9 offset:0
    v_mfma_f32_16x16x32_bf16 v[108:111], v[36:39], v[40:43], v[108:111]
    ds_read_b128 v[64:67], v9 offset:2048
    v_mfma_f32_16x16x32_bf16 v[112:115], v[24:27], v[44:47], v[112:115]
    ds_read_b128 v[68:71], v9 offset:4096
    v_mfma_f32_16x16x32_bf16 v[116:119], v[28:31], v[44:47], v[116:119]
    ds_read_b128 v[72:75], v9 offset:6144
    v_mfma_f32_16x16x32_bf16 v[120:123], v[32:35], v[44:47], v[120:123]
    ds_read_b64_tr_b16 v[80:81], v11 offset:10240
    v_mfma_f32_16x16x32_bf16 v[124:127], v[36:39], v[44:47], v[124:127]
    ds_read_b64_tr_b16 v[82:83], v11 offset:10496
    v_mfma_f32_16x16x32_bf16 v[128:131], v[24:27], v[48:51], v[128:131]
    ds_read_b64_tr_b16 v[84:85], v12 offset:10240
    v_mfma_f32_16x16x32_bf16 v[132:135], v[28:31], v[48:51], v[132:135]
    ds_read_b64_tr_b16 v[86:87], v12 offset:10496
    v_mfma_f32_16x16x32_bf16 v[136:139], v[32:35], v[48:51], v[136:139]
    ds_read_b64_tr_b16 v[88:89], v13 offset:10240
    v_mfma_f32_16x16x32_bf16 v[140:143], v[36:39], v[48:51], v[140:143]
    ds_read_b64_tr_b16 v[90:91], v13 offset:10496
    v_mfma_f32_16x16x32_bf16 v[144:147], v[24:27], v[52:55], v[144:147]
    ds_read_b64_tr_b16 v[92:93], v14 offset:10240
    v_mfma_f32_16x16x32_bf16 v[148:151], v[28:31], v[52:55], v[148:151]
    ds_read_b64_tr_b16 v[94:95], v14 offset:10496
    v_mfma_f32_16x16x32_bf16 v[152:155], v[32:35], v[52:55], v[152:155]
    v_mfma_f32_16x16x32_bf16 v[156:159], v[36:39], v[52:55], v[156:159]
    v_mfma_f32_16x16x32_bf16 v[160:163], v[24:27], v[56:59], v[160:163]
    v_mfma_f32_16x16x32_bf16 v[164:167], v[28:31], v[56:59], v[164:167]
    v_mfma_f32_16x16x32_bf16 v[168:171], v[32:35], v[56:59], v[168:171]
    v_mfma_f32_16x16x32_bf16 v[172:175], v[36:39], v[56:59], v[172:175]
    s_waitcnt lgkmcnt(0)
    v_mfma_f32_16x16x32_bf16 v[96:99], v[60:63], v[76:79], v[96:99]
    s_barrier
    ds_read_b64_tr_b16 v[40:41], v10 offset:36864
    v_mfma_f32_16x16x32_bf16 v[100:103], v[64:67], v[76:79], v[100:103]
    ds_read_b64_tr_b16 v[42:43], v10 offset:37120
    v_mfma_f32_16x16x32_bf16 v[104:107], v[68:71], v[76:79], v[104:107]
    ds_read_b128 v[24:27], v8 offset:36864
    v_mfma_f32_16x16x32_bf16 v[108:111], v[72:75], v[76:79], v[108:111]
    ds_read_b128 v[28:31], v8 offset:38912
    v_mfma_f32_16x16x32_bf16 v[112:115], v[60:63], v[80:83], v[112:115]
    ds_read_b128 v[32:35], v8 offset:40960
    v_mfma_f32_16x16x32_bf16 v[116:119], v[64:67], v[80:83], v[116:119]
    ds_read_b128 v[36:39], v8 offset:43008
    v_mfma_f32_16x16x32_bf16 v[120:123], v[68:71], v[80:83], v[120:123]
    ds_read_b64_tr_b16 v[44:45], v11 offset:36864
    v_mfma_f32_16x16x32_bf16 v[124:127], v[72:75], v[80:83], v[124:127]
    ds_read_b64_tr_b16 v[46:47], v11 offset:37120
    v_mfma_f32_16x16x32_bf16 v[128:131], v[60:63], v[84:87], v[128:131]
    ds_read_b64_tr_b16 v[48:49], v12 offset:36864
    v_mfma_f32_16x16x32_bf16 v[132:135], v[64:67], v[84:87], v[132:135]
    ds_read_b64_tr_b16 v[50:51], v12 offset:37120
    v_mfma_f32_16x16x32_bf16 v[136:139], v[68:71], v[84:87], v[136:139]
    ds_read_b64_tr_b16 v[52:53], v13 offset:36864
    v_mfma_f32_16x16x32_bf16 v[140:143], v[72:75], v[84:87], v[140:143]
    ds_read_b64_tr_b16 v[54:55], v13 offset:37120
    v_mfma_f32_16x16x32_bf16 v[144:147], v[60:63], v[88:91], v[144:147]
    ds_read_b64_tr_b16 v[56:57], v14 offset:36864
    v_mfma_f32_16x16x32_bf16 v[148:151], v[64:67], v[88:91], v[148:151]
    ds_read_b64_tr_b16 v[58:59], v14 offset:37120
    v_mfma_f32_16x16x32_bf16 v[152:155], v[68:71], v[88:91], v[152:155]
    v_mfma_f32_16x16x32_bf16 v[156:159], v[72:75], v[88:91], v[156:159]
    v_mfma_f32_16x16x32_bf16 v[160:163], v[60:63], v[92:95], v[160:163]
    v_mfma_f32_16x16x32_bf16 v[164:167], v[64:67], v[92:95], v[164:167]
    v_mfma_f32_16x16x32_bf16 v[168:171], v[68:71], v[92:95], v[168:171]
    v_mfma_f32_16x16x32_bf16 v[172:175], v[72:75], v[92:95], v[172:175]
    s_waitcnt lgkmcnt(0)
    v_mfma_f32_16x16x32_bf16 v[96:99], v[24:27], v[40:43], v[96:99]
    ds_read_b64_tr_b16 v[76:77], v10 offset:47104
    v_mfma_f32_16x16x32_bf16 v[100:103], v[28:31], v[40:43], v[100:103]
    ds_read_b64_tr_b16 v[78:79], v10 offset:47360
    v_mfma_f32_16x16x32_bf16 v[104:107], v[32:35], v[40:43], v[104:107]
    ds_read_b128 v[60:63], v9 offset:36864
    v_mfma_f32_16x16x32_bf16 v[108:111], v[36:39], v[40:43], v[108:111]
    ds_read_b128 v[64:67], v9 offset:38912
    v_mfma_f32_16x16x32_bf16 v[112:115], v[24:27], v[44:47], v[112:115]
    ds_read_b128 v[68:71], v9 offset:40960
    v_mfma_f32_16x16x32_bf16 v[116:119], v[28:31], v[44:47], v[116:119]
    ds_read_b128 v[72:75], v9 offset:43008
    v_mfma_f32_16x16x32_bf16 v[120:123], v[32:35], v[44:47], v[120:123]
    ds_read_b64_tr_b16 v[80:81], v11 offset:47104
    v_mfma_f32_16x16x32_bf16 v[124:127], v[36:39], v[44:47], v[124:127]
    ds_read_b64_tr_b16 v[82:83], v11 offset:47360
    v_mfma_f32_16x16x32_bf16 v[128:131], v[24:27], v[48:51], v[128:131]
    ds_read_b64_tr_b16 v[84:85], v12 offset:47104
    v_mfma_f32_16x16x32_bf16 v[132:135], v[28:31], v[48:51], v[132:135]
    ds_read_b64_tr_b16 v[86:87], v12 offset:47360
    v_mfma_f32_16x16x32_bf16 v[136:139], v[32:35], v[48:51], v[136:139]
    ds_read_b64_tr_b16 v[88:89], v13 offset:47104
    v_mfma_f32_16x16x32_bf16 v[140:143], v[36:39], v[48:51], v[140:143]
    ds_read_b64_tr_b16 v[90:91], v13 offset:47360
    v_mfma_f32_16x16x32_bf16 v[144:147], v[24:27], v[52:55], v[144:147]
    ds_read_b64_tr_b16 v[92:93], v14 offset:47104
    v_mfma_f32_16x16x32_bf16 v[148:151], v[28:31], v[52:55], v[148:151]
    ds_read_b64_tr_b16 v[94:95], v14 offset:47360
    v_mfma_f32_16x16x32_bf16 v[152:155], v[32:35], v[52:55], v[152:155]
    v_mfma_f32_16x16x32_bf16 v[156:159], v[36:39], v[52:55], v[156:159]
    v_mfma_f32_16x16x32_bf16 v[160:163], v[24:27], v[56:59], v[160:163]
    v_mfma_f32_16x16x32_bf16 v[164:167], v[28:31], v[56:59], v[164:167]
    v_mfma_f32_16x16x32_bf16 v[168:171], v[32:35], v[56:59], v[168:171]
    v_mfma_f32_16x16x32_bf16 v[172:175], v[36:39], v[56:59], v[172:175]
    s_waitcnt lgkmcnt(0)
    v_mfma_f32_16x16x32_bf16 v[96:99], v[60:63], v[76:79], v[96:99]
    v_add_u32 v8, s40, v8
    v_add_u32 v9, s40, v9
    v_add_u32 v10, s40, v10
    v_add_u32 v11, s40, v11
    v_add_u32 v12, s40, v12
    v_add_u32 v13, s40, v13
    v_add_u32 v14, s40, v14
    s_sub_u32 s40, 0, s40
    s_sub_u32 s41, s41, 1
    s_barrier
    s_cmp_eq_u32 s41, 0
    s_cbranch_scc1 L_gemm_last_6
    ds_read_b64_tr_b16 v[40:41], v10 offset:0
    v_mfma_f32_16x16x32_bf16 v[100:103], v[64:67], v[76:79], v[100:103]
    ds_read_b64_tr_b16 v[42:43], v10 offset:256
    v_mfma_f32_16x16x32_bf16 v[104:107], v[68:71], v[76:79], v[104:107]
    ds_read_b128 v[24:27], v8 offset:0
    v_mfma_f32_16x16x32_bf16 v[108:111], v[72:75], v[76:79], v[108:111]
    ds_read_b128 v[28:31], v8 offset:2048
    v_mfma_f32_16x16x32_bf16 v[112:115], v[60:63], v[80:83], v[112:115]
    ds_read_b128 v[32:35], v8 offset:4096
    v_mfma_f32_16x16x32_bf16 v[116:119], v[64:67], v[80:83], v[116:119]
    ds_read_b128 v[36:39], v8 offset:6144
    v_mfma_f32_16x16x32_bf16 v[120:123], v[68:71], v[80:83], v[120:123]
    ds_read_b64_tr_b16 v[44:45], v11 offset:0
    v_mfma_f32_16x16x32_bf16 v[124:127], v[72:75], v[80:83], v[124:127]
    ds_read_b64_tr_b16 v[46:47], v11 offset:256
    v_mfma_f32_16x16x32_bf16 v[128:131], v[60:63], v[84:87], v[128:131]
    ds_read_b64_tr_b16 v[48:49], v12 offset:0
    v_mfma_f32_16x16x32_bf16 v[132:135], v[64:67], v[84:87], v[132:135]
    ds_read_b64_tr_b16 v[50:51], v12 offset:256
    v_mfma_f32_16x16x32_bf16 v[136:139], v[68:71], v[84:87], v[136:139]
    ds_read_b64_tr_b16 v[52:53], v13 offset:0
    v_mfma_f32_16x16x32_bf16 v[140:143], v[72:75], v[84:87], v[140:143]
    ds_read_b64_tr_b16 v[54:55], v13 offset:256
    v_mfma_f32_16x16x32_bf16 v[144:147], v[60:63], v[88:91], v[144:147]
    ds_read_b64_tr_b16 v[56:57], v14 offset:0
    v_mfma_f32_16x16x32_bf16 v[148:151], v[64:67], v[88:91], v[148:151]
    ds_read_b64_tr_b16 v[58:59], v14 offset:256
    v_mfma_f32_16x16x32_bf16 v[152:155], v[68:71], v[88:91], v[152:155]
    v_mfma_f32_16x16x32_bf16 v[156:159], v[72:75], v[88:91], v[156:159]
    v_mfma_f32_16x16x32_bf16 v[160:163], v[60:63], v[92:95], v[160:163]
    v_mfma_f32_16x16x32_bf16 v[164:167], v[64:67], v[92:95], v[164:167]
    v_mfma_f32_16x16x32_bf16 v[168:171], v[68:71], v[92:95], v[168:171]
    v_mfma_f32_16x16x32_bf16 v[172:175], v[72:75], v[92:95], v[172:175]
    s_branch L_gemm_5
L_gemm_last_6:
    ds_read_b64_tr_b16 v[40:41], v10 offset:0
    ds_read_b64_tr_b16 v[42:43], v10 offset:256
    v_mfma_f32_16x16x32_bf16 v[100:103], v[64:67], v[76:79], v[100:103]
    ds_read_b128 v[24:27], v8 offset:0
    ds_read_b128 v[28:31], v8 offset:2048
    v_mfma_f32_16x16x32_bf16 v[104:107], v[68:71], v[76:79], v[104:107]
    ds_read_b128 v[32:35], v8 offset:4096
    ds_read_b128 v[36:39], v8 offset:6144
    v_mfma_f32_16x16x32_bf16 v[108:111], v[72:75], v[76:79], v[108:111]
    ds_read_b64_tr_b16 v[192:193], v10 offset:10240
    ds_read_b64_tr_b16 v[194:195], v10 offset:10496
    v_mfma_f32_16x16x32_bf16 v[112:115], v[60:63], v[80:83], v[112:115]
    ds_read_b128 v[176:179], v9 offset:0
    ds_read_b128 v[180:183], v9 offset:2048
    v_mfma_f32_16x16x32_bf16 v[116:119], v[64:67], v[80:83], v[116:119]
    ds_read_b128 v[184:187], v9 offset:4096
    ds_read_b128 v[188:191], v9 offset:6144
    v_mfma_f32_16x16x32_bf16 v[120:123], v[68:71], v[80:83], v[120:123]
    ds_read_b64_tr_b16 v[44:45], v11 offset:0
    ds_read_b64_tr_b16 v[46:47], v11 offset:256
    v_mfma_f32_16x16x32_bf16 v[124:127], v[72:75], v[80:83], v[124:127]
    ds_read_b64_tr_b16 v[196:197], v11 offset:10240
    ds_read_b64_tr_b16 v[198:199], v11 offset:10496
    v_mfma_f32_16x16x32_bf16 v[128:131], v[60:63], v[84:87], v[128:131]
    ds_read_b64_tr_b16 v[48:49], v12 offset:0
    ds_read_b64_tr_b16 v[50:51], v12 offset:256
    v_mfma_f32_16x16x32_bf16 v[132:135], v[64:67], v[84:87], v[132:135]
    ds_read_b64_tr_b16 v[200:201], v12 offset:10240
    v_mfma_f32_16x16x32_bf16 v[136:139], v[68:71], v[84:87], v[136:139]
    ds_read_b64_tr_b16 v[202:203], v12 offset:10496
    v_mfma_f32_16x16x32_bf16 v[140:143], v[72:75], v[84:87], v[140:143]
    ds_read_b64_tr_b16 v[52:53], v13 offset:0
    v_mfma_f32_16x16x32_bf16 v[144:147], v[60:63], v[88:91], v[144:147]
    ds_read_b64_tr_b16 v[54:55], v13 offset:256
    v_mfma_f32_16x16x32_bf16 v[148:151], v[64:67], v[88:91], v[148:151]
    ds_read_b64_tr_b16 v[204:205], v13 offset:10240
    v_mfma_f32_16x16x32_bf16 v[152:155], v[68:71], v[88:91], v[152:155]
    ds_read_b64_tr_b16 v[206:207], v13 offset:10496
    v_mfma_f32_16x16x32_bf16 v[156:159], v[72:75], v[88:91], v[156:159]
    ds_read_b64_tr_b16 v[56:57], v14 offset:0
    v_mfma_f32_16x16x32_bf16 v[160:163], v[60:63], v[92:95], v[160:163]
    ds_read_b64_tr_b16 v[58:59], v14 offset:256
    v_mfma_f32_16x16x32_bf16 v[164:167], v[64:67], v[92:95], v[164:167]
    ds_read_b64_tr_b16 v[208:209], v14 offset:10240
    v_mfma_f32_16x16x32_bf16 v[168:171], v[68:71], v[92:95], v[168:171]
    ds_read_b64_tr_b16 v[210:211], v14 offset:10496
    v_mfma_f32_16x16x32_bf16 v[172:175], v[72:75], v[92:95], v[172:175]
    s_barrier
    s_waitcnt lgkmcnt(0)
    v_mfma_f32_16x16x32_bf16 v[96:99], v[24:27], v[40:43], v[96:99]
    ds_read_b64_tr_b16 v[228:229], v10 offset:36864
    ds_read_b64_tr_b16 v[230:231], v10 offset:37120
    v_mfma_f32_16x16x32_bf16 v[100:103], v[28:31], v[40:43], v[100:103]
    ds_read_b128 v[212:215], v8 offset:36864
    ds_read_b128 v[216:219], v8 offset:38912
    v_mfma_f32_16x16x32_bf16 v[104:107], v[32:35], v[40:43], v[104:107]
    ds_read_b128 v[220:223], v8 offset:40960
    ds_read_b128 v[224:227], v8 offset:43008
    v_mfma_f32_16x16x32_bf16 v[108:111], v[36:39], v[40:43], v[108:111]
    ds_read_b64_tr_b16 v[76:77], v10 offset:47104
    ds_read_b64_tr_b16 v[78:79], v10 offset:47360
    v_mfma_f32_16x16x32_bf16 v[96:99], v[176:179], v[192:195], v[96:99]
    ds_read_b128 v[60:63], v9 offset:36864
    ds_read_b128 v[64:67], v9 offset:38912
    v_mfma_f32_16x16x32_bf16 v[100:103], v[180:183], v[192:195], v[100:103]
    ds_read_b128 v[68:71], v9 offset:40960
    ds_read_b128 v[72:75], v9 offset:43008
    v_mfma_f32_16x16x32_bf16 v[104:107], v[184:187], v[192:195], v[104:107]
    ds_read_b64_tr_b16 v[232:233], v11 offset:36864
    ds_read_b64_tr_b16 v[234:235], v11 offset:37120
    v_mfma_f32_16x16x32_bf16 v[108:111], v[188:191], v[192:195], v[108:111]
    ds_read_b64_tr_b16 v[80:81], v11 offset:47104
    ds_read_b64_tr_b16 v[82:83], v11 offset:47360
    s_waitcnt lgkmcnt(4)
    v_mfma_f32_16x16x32_bf16 v[96:99], v[212:215], v[228:231], v[96:99]
    ds_read_b64_tr_b16 v[236:237], v12 offset:36864
    ds_read_b64_tr_b16 v[238:239], v12 offset:37120
    v_mfma_f32_16x16x32_bf16 v[100:103], v[216:219], v[228:231], v[100:103]
    ds_read_b64_tr_b16 v[84:85], v12 offset:47104
    ds_read_b64_tr_b16 v[86:87], v12 offset:47360
    v_mfma_f32_16x16x32_bf16 v[104:107], v[220:223], v[228:231], v[104:107]
    ds_read_b64_tr_b16 v[240:241], v13 offset:36864
    ds_read_b64_tr_b16 v[242:243], v13 offset:37120
    v_mfma_f32_16x16x32_bf16 v[108:111], v[224:227], v[228:231], v[108:111]
    ds_read_b64_tr_b16 v[88:89], v13 offset:47104
    ds_read_b64_tr_b16 v[90:91], v13 offset:47360
    v_mfma_f32_16x16x32_bf16 v[96:99], v[60:63], v[76:79], v[96:99]
    ds_read_b64_tr_b16 v[244:245], v14 offset:36864
    ds_read_b64_tr_b16 v[246:247], v14 offset:37120
    v_mfma_f32_16x16x32_bf16 v[100:103], v[64:67], v[76:79], v[100:103]
    ds_read_b64_tr_b16 v[92:93], v14 offset:47104
    ds_read_b64_tr_b16 v[94:95], v14 offset:47360
    v_mfma_f32_16x16x32_bf16 v[104:107], v[68:71], v[76:79], v[104:107]
    v_mfma_f32_16x16x32_bf16 v[108:111], v[72:75], v[76:79], v[108:111]
    v_mfma_f32_16x16x32_bf16 v[112:115], v[24:27], v[44:47], v[112:115]
    v_mfma_f32_16x16x32_bf16 v[116:119], v[28:31], v[44:47], v[116:119]
    v_mfma_f32_16x16x32_bf16 v[120:123], v[32:35], v[44:47], v[120:123]
    v_mfma_f32_16x16x32_bf16 v[124:127], v[36:39], v[44:47], v[124:127]
    v_mfma_f32_16x16x32_bf16 v[112:115], v[176:179], v[196:199], v[112:115]
    v_cvt_pk_bf16_f32 v96, v96, v97
    v_cvt_pk_bf16_f32 v97, v98, v99
    v_mfma_f32_16x16x32_bf16 v[116:119], v[180:183], v[196:199], v[116:119]
    v_cvt_pk_bf16_f32 v98, v100, v101
    v_cvt_pk_bf16_f32 v99, v102, v103
    v_mfma_f32_16x16x32_bf16 v[120:123], v[184:187], v[196:199], v[120:123]
    v_cvt_pk_bf16_f32 v100, v104, v105
    v_cvt_pk_bf16_f32 v101, v106, v107
    v_mfma_f32_16x16x32_bf16 v[124:127], v[188:191], v[196:199], v[124:127]
    v_cvt_pk_bf16_f32 v102, v108, v109
    v_cvt_pk_bf16_f32 v103, v110, v111
    s_waitcnt lgkmcnt(0)
    v_mfma_f32_16x16x32_bf16 v[112:115], v[212:215], v[232:235], v[112:115]
    s_nop 0
    v_permlane32_swap_b32 v96, v98
    v_mfma_f32_16x16x32_bf16 v[116:119], v[216:219], v[232:235], v[116:119]
    v_permlane32_swap_b32 v97, v99
    v_permlane32_swap_b32 v100, v102
    v_mfma_f32_16x16x32_bf16 v[120:123], v[220:223], v[232:235], v[120:123]
    v_permlane32_swap_b32 v101, v103
    buffer_store_dwordx4 v[96:99], v16, s[28:31], s47 offen offset:0 sc1
    v_mfma_f32_16x16x32_bf16 v[124:127], v[224:227], v[232:235], v[124:127]
    buffer_store_dwordx4 v[100:103], v16, s[28:31], s47 offen offset:2560 sc1
    v_mfma_f32_16x16x32_bf16 v[112:115], v[60:63], v[80:83], v[112:115]
    v_mfma_f32_16x16x32_bf16 v[116:119], v[64:67], v[80:83], v[116:119]
    v_mfma_f32_16x16x32_bf16 v[120:123], v[68:71], v[80:83], v[120:123]
    v_mfma_f32_16x16x32_bf16 v[124:127], v[72:75], v[80:83], v[124:127]
    v_mfma_f32_16x16x32_bf16 v[128:131], v[24:27], v[48:51], v[128:131]
    v_mfma_f32_16x16x32_bf16 v[132:135], v[28:31], v[48:51], v[132:135]
    v_mfma_f32_16x16x32_bf16 v[136:139], v[32:35], v[48:51], v[136:139]
    v_mfma_f32_16x16x32_bf16 v[140:143], v[36:39], v[48:51], v[140:143]
    v_mfma_f32_16x16x32_bf16 v[128:131], v[176:179], v[200:203], v[128:131]
    v_cvt_pk_bf16_f32 v112, v112, v113
    v_cvt_pk_bf16_f32 v113, v114, v115
    v_mfma_f32_16x16x32_bf16 v[132:135], v[180:183], v[200:203], v[132:135]
    v_cvt_pk_bf16_f32 v114, v116, v117
    v_cvt_pk_bf16_f32 v115, v118, v119
    v_mfma_f32_16x16x32_bf16 v[136:139], v[184:187], v[200:203], v[136:139]
    v_cvt_pk_bf16_f32 v116, v120, v121
    v_cvt_pk_bf16_f32 v117, v122, v123
    v_mfma_f32_16x16x32_bf16 v[140:143], v[188:191], v[200:203], v[140:143]
    v_cvt_pk_bf16_f32 v118, v124, v125
    v_cvt_pk_bf16_f32 v119, v126, v127
    v_mfma_f32_16x16x32_bf16 v[128:131], v[212:215], v[236:239], v[128:131]
    s_nop 0
    v_permlane32_swap_b32 v112, v114
    v_mfma_f32_16x16x32_bf16 v[132:135], v[216:219], v[236:239], v[132:135]
    v_permlane32_swap_b32 v113, v115
    v_permlane32_swap_b32 v116, v118
    v_mfma_f32_16x16x32_bf16 v[136:139], v[220:223], v[236:239], v[136:139]
    v_permlane32_swap_b32 v117, v119
    buffer_store_dwordx4 v[112:115], v17, s[28:31], s47 offen offset:0 sc1
    v_mfma_f32_16x16x32_bf16 v[140:143], v[224:227], v[236:239], v[140:143]
    buffer_store_dwordx4 v[116:119], v17, s[28:31], s47 offen offset:2560 sc1
    v_mfma_f32_16x16x32_bf16 v[128:131], v[60:63], v[84:87], v[128:131]
    v_mfma_f32_16x16x32_bf16 v[132:135], v[64:67], v[84:87], v[132:135]
    v_mfma_f32_16x16x32_bf16 v[136:139], v[68:71], v[84:87], v[136:139]
    v_mfma_f32_16x16x32_bf16 v[140:143], v[72:75], v[84:87], v[140:143]
    v_mfma_f32_16x16x32_bf16 v[144:147], v[24:27], v[52:55], v[144:147]
    v_mfma_f32_16x16x32_bf16 v[148:151], v[28:31], v[52:55], v[148:151]
    v_mfma_f32_16x16x32_bf16 v[152:155], v[32:35], v[52:55], v[152:155]
    v_mfma_f32_16x16x32_bf16 v[156:159], v[36:39], v[52:55], v[156:159]
    v_mfma_f32_16x16x32_bf16 v[144:147], v[176:179], v[204:207], v[144:147]
    v_cvt_pk_bf16_f32 v128, v128, v129
    v_cvt_pk_bf16_f32 v129, v130, v131
    v_mfma_f32_16x16x32_bf16 v[148:151], v[180:183], v[204:207], v[148:151]
    v_cvt_pk_bf16_f32 v130, v132, v133
    v_cvt_pk_bf16_f32 v131, v134, v135
    v_mfma_f32_16x16x32_bf16 v[152:155], v[184:187], v[204:207], v[152:155]
    v_cvt_pk_bf16_f32 v132, v136, v137
    v_cvt_pk_bf16_f32 v133, v138, v139
    v_mfma_f32_16x16x32_bf16 v[156:159], v[188:191], v[204:207], v[156:159]
    v_cvt_pk_bf16_f32 v134, v140, v141
    v_cvt_pk_bf16_f32 v135, v142, v143
    v_mfma_f32_16x16x32_bf16 v[144:147], v[212:215], v[240:243], v[144:147]
    s_nop 0
    v_permlane32_swap_b32 v128, v130
    v_mfma_f32_16x16x32_bf16 v[148:151], v[216:219], v[240:243], v[148:151]
    v_permlane32_swap_b32 v129, v131
    v_permlane32_swap_b32 v132, v134
    v_mfma_f32_16x16x32_bf16 v[152:155], v[220:223], v[240:243], v[152:155]
    v_permlane32_swap_b32 v133, v135
    buffer_store_dwordx4 v[128:131], v18, s[28:31], s47 offen offset:0 sc1
    v_mfma_f32_16x16x32_bf16 v[156:159], v[224:227], v[240:243], v[156:159]
    buffer_store_dwordx4 v[132:135], v18, s[28:31], s47 offen offset:2560 sc1
    v_mfma_f32_16x16x32_bf16 v[144:147], v[60:63], v[88:91], v[144:147]
    v_mfma_f32_16x16x32_bf16 v[148:151], v[64:67], v[88:91], v[148:151]
    v_mfma_f32_16x16x32_bf16 v[152:155], v[68:71], v[88:91], v[152:155]
    v_mfma_f32_16x16x32_bf16 v[156:159], v[72:75], v[88:91], v[156:159]
    v_mfma_f32_16x16x32_bf16 v[160:163], v[24:27], v[56:59], v[160:163]
    v_mfma_f32_16x16x32_bf16 v[164:167], v[28:31], v[56:59], v[164:167]
    v_mfma_f32_16x16x32_bf16 v[168:171], v[32:35], v[56:59], v[168:171]
    v_mfma_f32_16x16x32_bf16 v[172:175], v[36:39], v[56:59], v[172:175]
    v_mfma_f32_16x16x32_bf16 v[160:163], v[176:179], v[208:211], v[160:163]
    v_cvt_pk_bf16_f32 v144, v144, v145
    v_cvt_pk_bf16_f32 v145, v146, v147
    v_mfma_f32_16x16x32_bf16 v[164:167], v[180:183], v[208:211], v[164:167]
    v_cvt_pk_bf16_f32 v146, v148, v149
    v_cvt_pk_bf16_f32 v147, v150, v151
    v_mfma_f32_16x16x32_bf16 v[168:171], v[184:187], v[208:211], v[168:171]
    v_cvt_pk_bf16_f32 v148, v152, v153
    v_cvt_pk_bf16_f32 v149, v154, v155
    v_mfma_f32_16x16x32_bf16 v[172:175], v[188:191], v[208:211], v[172:175]
    v_cvt_pk_bf16_f32 v150, v156, v157
    v_cvt_pk_bf16_f32 v151, v158, v159
    v_mfma_f32_16x16x32_bf16 v[160:163], v[212:215], v[244:247], v[160:163]
    s_nop 0
    v_permlane32_swap_b32 v144, v146
    v_mfma_f32_16x16x32_bf16 v[164:167], v[216:219], v[244:247], v[164:167]
    v_permlane32_swap_b32 v145, v147
    v_permlane32_swap_b32 v148, v150
    v_mfma_f32_16x16x32_bf16 v[168:171], v[220:223], v[244:247], v[168:171]
    v_permlane32_swap_b32 v149, v151
    buffer_store_dwordx4 v[144:147], v19, s[28:31], s47 offen offset:0 sc1
    v_mfma_f32_16x16x32_bf16 v[172:175], v[224:227], v[244:247], v[172:175]
    buffer_store_dwordx4 v[148:151], v19, s[28:31], s47 offen offset:2560 sc1
    v_mfma_f32_16x16x32_bf16 v[160:163], v[60:63], v[92:95], v[160:163]
    v_mfma_f32_16x16x32_bf16 v[164:167], v[64:67], v[92:95], v[164:167]
    v_mfma_f32_16x16x32_bf16 v[168:171], v[68:71], v[92:95], v[168:171]
    v_mfma_f32_16x16x32_bf16 v[172:175], v[72:75], v[92:95], v[172:175]
    s_nop 7
    v_cvt_pk_bf16_f32 v160, v160, v161
    v_cvt_pk_bf16_f32 v161, v162, v163
    v_cvt_pk_bf16_f32 v162, v164, v165
    v_cvt_pk_bf16_f32 v163, v166, v167
    v_cvt_pk_bf16_f32 v164, v168, v169
    v_cvt_pk_bf16_f32 v165, v170, v171
    v_cvt_pk_bf16_f32 v166, v172, v173
    v_cvt_pk_bf16_f32 v167, v174, v175
    s_nop 0
    v_permlane32_swap_b32 v160, v162
    v_permlane32_swap_b32 v161, v163
    v_permlane32_swap_b32 v164, v166
    v_permlane32_swap_b32 v165, v167
    buffer_store_dwordx4 v[160:163], v20, s[28:31], s47 offen offset:0 sc1
    buffer_store_dwordx4 v[164:167], v20, s[28:31], s47 offen offset:2560 sc1
    s_branch L_A_done
L_prep:
    s_sub_u32 s40, s25, 24
    s_and_b32 s27, s40, 1
    s_lshr_b32 s26, s40, 1
    s_lshl_b32 s26, s26, 3
    s_add_u32 s26, s26, s24
    s_add_u32 s36, s16, 11617280
    s_addc_u32 s37, s17, 0
    s_mov_b32 s38, 1486848
    s_mov_b32 s39, 0x00020000
    s_cmp_ge_u32 s3, 5
    s_cbranch_scc1 L_fold_skip
    s_mov_b32 s28, s10
    s_mov_b32 s29, s11
    s_mov_b32 s30, 2621440
    s_mov_b32 s31, 0x00020000
    s_lshr_b32 s42, s26, 1
    s_lshl_b32 s42, s42, 5
    s_and_b32 s43, s26, 1
    s_add_u32 s42, s42, s43
    v_lshrrev_b32 v2, 3, v1
    v_and_b32 v3, 7, v1
    v_lshl_add_u32 v4, v2, 1, s42
    v_mul_u32_u24 v5, 1280, v4
    v_lshlrev_b32 v6, 4, v3
    v_add_u32 v10, v5, v6
    v_sub_u32 v7, v6, v5
    s_lshl_b32 s44, s27, 1
    s_add_u32 s44, s44, s3
    s_cmp_ge_u32 s44, 5
    s_cselect_b32 s45, 5, 0
    s_sub_u32 s44, s44, s45
    s_lshl_b32 s44, s44, 7
    s_add_u32 s45, s44, 20480
    v_add_u32 v11, 2621440, v7
    v_add_u32 v12, 1310720, v7
    v_cmp_ne_u32 vcc, 0, v4
    v_mov_b32 v8, 1073741824
    v_add_u32 v9, 1310720, v10
    v_cndmask_b32 v13, v8, v9, vcc
    buffer_load_dwordx4 v[32:35], v10, s[28:31], s44 offen offset:0
    buffer_load_dwordx4 v[40:43], v11, s[28:31], s44 offen offset:0
    buffer_load_dwordx4 v[48:51], v12, s[28:31], s44 offen offset:0
    buffer_load_dwordx4 v[56:59], v13, s[28:31], s44 offen offset:0
    buffer_load_dwordx4 v[36:39], v10, s[28:31], s44 offen offset:640
    buffer_load_dwordx4 v[44:47], v11, s[28:31], s44 offen offset:640
    buffer_load_dwordx4 v[52:55], v12, s[28:31], s44 offen offset:640
    buffer_load_dwordx4 v[60:63], v13, s[28:31], s44 offen offset:640
    v_subrev_u32 v11, 20480, v11
    v_subrev_u32 v12, 20480, v12
    buffer_load_dwordx4 v[64:67], v10, s[28:31], s45 offen offset:0
    buffer_load_dwordx4 v[72:75], v11, s[28:31], s44 offen offset:0
    buffer_load_dwordx4 v[80:83], v12, s[28:31], s44 offen offset:0
    buffer_load_dwordx4 v[88:91], v9, s[28:31], s45 offen offset:0
    buffer_load_dwordx4 v[68:71], v10, s[28:31], s45 offen offset:640
    buffer_load_dwordx4 v[76:79], v11, s[28:31], s44 offen offset:640
    buffer_load_dwordx4 v[84:87], v12, s[28:31], s44 offen offset:640
    buffer_load_dwordx4 v[92:95], v9, s[28:31], s45 offen offset:640
    s_cmp_lg_u32 s26, 0
    s_cbranch_scc1 L_fold_nx
    v_add_u32 v14, 655360, v6
    v_add_u32 v15, 1966080, v6
    v_cndmask_b32 v14, v14, v8, vcc
    v_cndmask_b32 v15, v15, v8, vcc
    buffer_load_dwordx4 v[96:99], v14, s[28:31], s44 offen offset:0
    buffer_load_dwordx4 v[100:103], v14, s[28:31], s44 offen offset:640
    buffer_load_dwordx4 v[104:107], v15, s[28:31], s44 offen offset:0
    buffer_load_dwordx4 v[108:111], v15, s[28:31], s44 offen offset:640
L_fold_nx:
    v_and_b32 v5, 3, v2
    v_lshrrev_b32 v4, 2, v2
    v_lshl_or_b32 v5, v4, 3, v5
    v_xor_b32 v5, v5, v3
    v_and_b32 v4, 1, v3
    v_lshl_add_u32 v5, v4, 5, v5
    v_lshlrev_b32 v5, 4, v5
    v_lshrrev_b32 v4, 1, v3
    v_lshl_add_u32 v5, v4, 10, v5
    s_lshl_b32 s45, s44, 5
    v_add_u32 v16, s45, v5
    v_xor_b32 v18, 64, v16
    v_add_u32 v5, s44, v6
    v_add_u32 v17, 40960, v5
    v_lshlrev_b32 v6, 4, v1
    v_add_u32 v6, 43008, v6
    v_cndmask_b32 v17, v17, v6, vcc
L_fold_skip:
    v_and_b32 v2, 31, v1
    v_lshrrev_b32 v3, 5, v1
    v_lshlrev_b32 v15, 4, v1
    s_lshr_b32 s40, s3, 1
    s_add_u32 s40, s40, 2
    s_and_b32 s41, s3, 1
    s_cmp_lt_u32 s3, 4
    s_cselect_b32 s49, s3, s40
    s_cselect_b32 s50, 0, s41
    s_lshl_b32 s54, s49, 6
    s_add_u32 s54, s54, s27
    v_lshl_add_u32 v4, v2, 1, s54
    s_mul_i32 s52, s50, 20480
    v_xor_b32 v5, 0, v3
    v_xor_b32 v5, v5, v2
    v_lshl_add_u32 v5, v3, 5, v5
    v_lshlrev_b32 v5, 4, v5
    v_add_u32 v5, 0, v5
    v_add_u32 v10, s52, v5
    v_xor_b32 v5, 2, v3
    v_xor_b32 v5, v5, v2
    v_lshl_add_u32 v5, v3, 5, v5
    v_lshlrev_b32 v5, 4, v5
    v_add_u32 v5, 1024, v5
    v_add_u32 v11, s52, v5
    v_xor_b32 v5, 4, v3
    v_xor_b32 v5, v5, v2
    v_lshl_add_u32 v5, v3, 5, v5
    v_lshlrev_b32 v5, 4, v5
    v_add_u32 v5, 2048, v5
    v_add_u32 v12, s52, v5
    v_xor_b32 v5, 6, v3
    v_xor_b32 v5, v5, v2
    v_lshl_add_u32 v5, v3, 5, v5
    v_lshlrev_b32 v5, 4, v5
    v_add_u32 v5, 3072, v5
    v_add_u32 v13, s52, v5
    v_lshlrev_b32 v14, 4, v3
    v_add_u32 v14, 40960, v14
    s_mov_b32 s52, 986500301
    s_cmp_lg_u32 s50, 0
    s_cselect_b32 s53, 0x3e800000, 0
    v_lshlrev_b32 v5, 3, v3
    v_mul_u32_u24 v5, v4, v5
    v_cvt_f32_u32 v5, v5
    v_cvt_f32_u32 v4, v4
    v_mul_f32 v6, 0x41800000, v4
    v_mul_f32 v112, s52, v5
    v_sub_f32 v7, v5, v6
    v_mul_f32 v120, s52, v7
    v_add_f32 v5, v5, v4
    v_mul_f32 v113, s52, v5
    v_sub_f32 v7, v5, v6
    v_mul_f32 v121, s52, v7
    v_add_f32 v5, v5, v4
    v_mul_f32 v114, s52, v5
    v_sub_f32 v7, v5, v6
    v_mul_f32 v122, s52, v7
    v_add_f32 v5, v5, v4
    v_mul_f32 v115, s52, v5
    v_sub_f32 v7, v5, v6
    v_mul_f32 v123, s52, v7
    v_add_f32 v5, v5, v4
    v_mul_f32 v116, s52, v5
    v_sub_f32 v7, v5, v6
    v_mul_f32 v124, s52, v7
    v_add_f32 v5, v5, v4
    v_mul_f32 v117, s52, v5
    v_sub_f32 v7, v5, v6
    v_mul_f32 v125, s52, v7
    v_add_f32 v5, v5, v4
    v_mul_f32 v118, s52, v5
    v_sub_f32 v7, v5, v6
    v_mul_f32 v126, s52, v7
    v_add_f32 v5, v5, v4
    v_mul_f32 v119, s52, v5
    v_sub_f32 v7, v5, v6
    v_mul_f32 v127, s52, v7
    v_mul_f32 v6, s52, v6
    v_fract_f32 v6, v6
    v_fract_f32 v112, v112
    v_fract_f32 v113, v113
    v_fract_f32 v114, v114
    v_fract_f32 v115, v115
    v_fract_f32 v116, v116
    v_fract_f32 v117, v117
    v_fract_f32 v118, v118
    v_fract_f32 v119, v119
    v_fract_f32 v120, v120
    v_fract_f32 v121, v121
    v_fract_f32 v122, v122
    v_fract_f32 v123, v123
    v_fract_f32 v124, v124
    v_fract_f32 v125, v125
    v_fract_f32 v126, v126
    v_fract_f32 v127, v127
    v_cos_f32 v19, v6
    v_sin_f32 v192, v112
    v_sin_f32 v193, v113
    v_sin_f32 v194, v114
    v_sin_f32 v195, v115
    v_sin_f32 v196, v116
    v_sin_f32 v197, v117
    v_sin_f32 v198, v118
    v_sin_f32 v199, v119
    v_sin_f32 v200, v120
    v_sin_f32 v201, v121
    v_sin_f32 v202, v122
    v_sin_f32 v203, v123
    v_sin_f32 v204, v124
    v_sin_f32 v205, v125
    v_sin_f32 v206, v126
    v_sin_f32 v207, v127
    v_subrev_f32 v112, s53, v112
    v_subrev_f32 v113, s53, v113
    v_subrev_f32 v114, s53, v114
    v_subrev_f32 v115, s53, v115
    v_subrev_f32 v116, s53, v116
    v_subrev_f32 v117, s53, v117
    v_subrev_f32 v118, s53, v118
    v_subrev_f32 v119, s53, v119
    v_subrev_f32 v120, s53, v120
    v_subrev_f32 v121, s53, v121
    v_subrev_f32 v122, s53, v122
    v_subrev_f32 v123, s53, v123
    v_subrev_f32 v124, s53, v124
    v_subrev_f32 v125, s53, v125
    v_subrev_f32 v126, s53, v126
    v_subrev_f32 v127, s53, v127
    v_cos_f32 v176, v112
    v_cos_f32 v177, v113
    v_cos_f32 v178, v114
    v_cos_f32 v179, v115
    v_cos_f32 v180, v116
    v_cos_f32 v181, v117
    v_cos_f32 v182, v118
    v_cos_f32 v183, v119
    v_cos_f32 v184, v120
    v_cos_f32 v185, v121
    v_cos_f32 v186, v122
    v_cos_f32 v187, v123
    v_cos_f32 v188, v124
    v_cos_f32 v189, v125
    v_cos_f32 v190, v126
    v_cos_f32 v191, v127
    v_add_f32 v19, v19, v19
    v_mov_b32 v224, 0
    v_mov_b32 v225, 0
    v_mov_b32 v226, 0
    v_mov_b32 v227, 0
    v_mov_b32 v228, 0
    v_mov_b32 v229, 0
    v_mov_b32 v230, 0
    v_mov_b32 v231, 0
    v_mov_b32 v232, 0
    v_mov_b32 v233, 0
    v_mov_b32 v234, 0
    v_mov_b32 v235, 0
    v_mov_b32 v236, 0
    v_mov_b32 v237, 0
    v_mov_b32 v238, 0
    v_mov_b32 v239, 0
    v_mov_b32 v240, 0
    v_mov_b32 v241, 0
    v_mov_b32 v242, 0
    v_mov_b32 v243, 0
    v_mov_b32 v244, 0
    v_mov_b32 v245, 0
    v_mov_b32 v246, 0
    v_mov_b32 v247, 0
    v_mov_b32 v248, 0
    v_mov_b32 v249, 0
    v_mov_b32 v250, 0
    v_mov_b32 v251, 0
    v_mov_b32 v252, 0
    v_mov_b32 v253, 0
    v_mov_b32 v254, 0
    v_mov_b32 v255, 0
    v_cvt_pk_bf16_f32 v208, v176, v177
    v_cvt_pk_bf16_f32 v209, v178, v179
    v_cvt_pk_bf16_f32 v210, v180, v181
    v_cvt_pk_bf16_f32 v211, v182, v183
    v_cvt_pk_bf16_f32 v216, v192, v193
    v_cvt_pk_bf16_f32 v217, v194, v195
    v_cvt_pk_bf16_f32 v218, v196, v197
    v_cvt_pk_bf16_f32 v219, v198, v199
    s_cmp_lt_u32 s3, 5
    s_cbranch_scc1 L_fold_go
    s_sub_u32 s53, s2, 192
    s_mul_i32 s53, s53, 3
    s_add_u32 s53, s53, s3
    s_sub_u32 s53, s53, 5
    v_lshlrev_b32 v23, 4, v3
    s_mov_b32 s55, 973078528
    v_cmp_gt_u32 vcc, 32, v1
    s_add_u32 s54, s53, 0
    s_lshr_b32 s41, s54, 5
    s_and_b32 s58, s54, 31
    s_lshr_b32 s59, s41, 1
    s_lshl_b32 s59, s59, 6
    s_and_b32 s47, s41, 1
    s_add_u32 s59, s59, s47
    v_lshl_add_u32 v4, v2, 1, s59
    s_lshr_b32 s47, s58, 4
    s_mul_i32 s45, s41, 65
    s_add_u32 s45, s45, s58
    s_add_u32 s46, s45, 33
    s_add_u32 s45, s45, s47
    s_lshl_b32 s45, s45, 10
    s_lshl_b32 s46, s46, 10
    s_and_b32 s48, s58, 15
    s_lshl_b32 s48, s48, 5
    s_add_u32 s48, s48, s47
    v_add_u32 v5, s48, v23
    v_mul_u32_u24 v5, v4, v5
    v_cvt_f32_u32 v5, v5
    v_cvt_f32_u32 v4, v4
    v_mul_f32 v120, s55, v5
    v_fma_f32 v5, 2.0, v4, v5
    v_mul_f32 v121, s55, v5
    v_fma_f32 v5, 2.0, v4, v5
    v_mul_f32 v122, s55, v5
    v_fma_f32 v5, 2.0, v4, v5
    v_mul_f32 v123, s55, v5
    v_fma_f32 v5, 2.0, v4, v5
    v_mul_f32 v124, s55, v5
    v_fma_f32 v5, 2.0, v4, v5
    v_mul_f32 v125, s55, v5
    v_fma_f32 v5, 2.0, v4, v5
    v_mul_f32 v126, s55, v5
    v_fma_f32 v5, 2.0, v4, v5
    v_mul_f32 v127, s55, v5
    v_fract_f32 v120, v120
    v_fract_f32 v121, v121
    v_fract_f32 v122, v122
    v_fract_f32 v123, v123
    v_fract_f32 v124, v124
    v_fract_f32 v125, v125
    v_fract_f32 v126, v126
    v_fract_f32 v127, v127
    v_cos_f32 v128, v120
    v_cos_f32 v129, v121
    v_cos_f32 v130, v122
    v_cos_f32 v131, v123
    v_cos_f32 v132, v124
    v_cos_f32 v133, v125
    v_cos_f32 v134, v126
    v_cos_f32 v135, v127
    s_cmp_lg_u32 s58, 0
    s_cbranch_scc1 L_gen_plain_7
    v_mul_f32 v6, 0x3e800000, v4
    v_fract_f32 v6, v6
    v_cndmask_b32 v120, v120, v6, vcc
    v_cos_f32 v7, v6
    v_mov_b32 v25, 0
    v_mov_b32 v26, 0
    v_mov_b32 v27, 0
    v_cndmask_b32 v7, 0, v7, vcc
    v_cvt_pk_bf16_f32 v24, v7, 0
L_gen_plain_7:
    v_sin_f32 v120, v120
    v_sin_f32 v121, v121
    v_sin_f32 v122, v122
    v_sin_f32 v123, v123
    v_sin_f32 v124, v124
    v_sin_f32 v125, v125
    v_sin_f32 v126, v126
    v_sin_f32 v127, v127
    v_cvt_pk_bf16_f32 v48, v128, v129
    v_cvt_pk_bf16_f32 v49, v130, v131
    v_cvt_pk_bf16_f32 v50, v132, v133
    v_cvt_pk_bf16_f32 v51, v134, v135
    v_cvt_pk_bf16_f32 v52, v120, v121
    v_cvt_pk_bf16_f32 v53, v122, v123
    v_cvt_pk_bf16_f32 v54, v124, v125
    v_cvt_pk_bf16_f32 v55, v126, v127
    s_mov_b32 s40, s45
    s_mov_b32 s42, s46
    s_add_u32 s54, s53, 192
    s_lshr_b32 s41, s54, 5
    s_and_b32 s58, s54, 31
    s_lshr_b32 s59, s41, 1
    s_lshl_b32 s59, s59, 6
    s_and_b32 s47, s41, 1
    s_add_u32 s59, s59, s47
    v_lshl_add_u32 v4, v2, 1, s59
    s_lshr_b32 s47, s58, 4
    s_mul_i32 s45, s41, 65
    s_add_u32 s45, s45, s58
    s_add_u32 s46, s45, 33
    s_add_u32 s45, s45, s47
    s_lshl_b32 s45, s45, 10
    s_lshl_b32 s46, s46, 10
    s_and_b32 s48, s58, 15
    s_lshl_b32 s48, s48, 5
    s_add_u32 s48, s48, s47
    v_add_u32 v5, s48, v23
    v_mul_u32_u24 v5, v4, v5
    v_cvt_f32_u32 v5, v5
    v_cvt_f32_u32 v4, v4
    v_mul_f32 v120, s55, v5
    v_fma_f32 v5, 2.0, v4, v5
    v_mul_f32 v121, s55, v5
    v_fma_f32 v5, 2.0, v4, v5
    v_mul_f32 v122, s55, v5
    v_fma_f32 v5, 2.0, v4, v5
    v_mul_f32 v123, s55, v5
    v_fma_f32 v5, 2.0, v4, v5
    v_mul_f32 v124, s55, v5
    v_fma_f32 v5, 2.0, v4, v5
    v_mul_f32 v125, s55, v5
    v_fma_f32 v5, 2.0, v4, v5
    v_mul_f32 v126, s55, v5
    v_fma_f32 v5, 2.0, v4, v5
    v_mul_f32 v127, s55, v5
    v_fract_f32 v120, v120
    v_fract_f32 v121, v121
    v_fract_f32 v122, v122
    v_fract_f32 v123, v123
    v_fract_f32 v124, v124
    v_fract_f32 v125, v125
    v_fract_f32 v126, v126
    v_fract_f32 v127, v127
    v_cos_f32 v128, v120
    v_cos_f32 v129, v121
    v_cos_f32 v130, v122
    v_cos_f32 v131, v123
    v_cos_f32 v132, v124
    v_cos_f32 v133, v125
    v_cos_f32 v134, v126
    v_cos_f32 v135, v127
    s_cmp_lg_u32 s58, 0
    s_cbranch_scc1 L_gen_plain_8
    v_mul_f32 v6, 0x3e800000, v4
    v_fract_f32 v6, v6
    v_cndmask_b32 v120, v120, v6, vcc
    v_cos_f32 v7, v6
    v_mov_b32 v29, 0
    v_mov_b32 v30, 0
    v_mov_b32 v31, 0
    v_cndmask_b32 v7, 0, v7, vcc
    v_cvt_pk_bf16_f32 v28, v7, 0
L_gen_plain_8:
    v_sin_f32 v120, v120
    v_sin_f32 v121, v121
    v_sin_f32 v122, v122
    v_sin_f32 v123, v123
    v_sin_f32 v124, v124
    v_sin_f32 v125, v125
    v_sin_f32 v126, v126
    v_sin_f32 v127, v127
    v_cvt_pk_bf16_f32 v56, v128, v129
    v_cvt_pk_bf16_f32 v57, v130, v131
    v_cvt_pk_bf16_f32 v58, v132, v133
    v_cvt_pk_bf16_f32 v59, v134, v135
    v_cvt_pk_bf16_f32 v60, v120, v121
    v_cvt_pk_bf16_f32 v61, v122, v123
    v_cvt_pk_bf16_f32 v62, v124, v125
    v_cvt_pk_bf16_f32 v63, v126, v127
    s_mov_b32 s43, s45
    s_mov_b32 s44, s46
    s_cmp_ge_u32 s53, 160
    s_cbranch_scc1 L_sw_gen_done
    s_add_u32 s54, s53, 384
    s_lshr_b32 s41, s54, 5
    s_and_b32 s58, s54, 31
    s_lshr_b32 s59, s41, 1
    s_lshl_b32 s59, s59, 6
    s_and_b32 s47, s41, 1
    s_add_u32 s59, s59, s47
    v_lshl_add_u32 v4, v2, 1, s59
    s_lshr_b32 s47, s58, 4
    s_mul_i32 s45, s41, 65
    s_add_u32 s45, s45, s58
    s_add_u32 s46, s45, 33
    s_add_u32 s45, s45, s47
    s_lshl_b32 s45, s45, 10
    s_lshl_b32 s46, s46, 10
    s_and_b32 s48, s58, 15
    s_lshl_b32 s48, s48, 5
    s_add_u32 s48, s48, s47
    v_add_u32 v5, s48, v23
    v_mul_u32_u24 v5, v4, v5
    v_cvt_f32_u32 v5, v5
    v_cvt_f32_u32 v4, v4
    v_mul_f32 v120, s55, v5
    v_fma_f32 v5, 2.0, v4, v5
    v_mul_f32 v121, s55, v5
    v_fma_f32 v5, 2.0, v4, v5
    v_mul_f32 v122, s55, v5
    v_fma_f32 v5, 2.0, v4, v5
    v_mul_f32 v123, s55, v5
    v_fma_f32 v5, 2.0, v4, v5
    v_mul_f32 v124, s55, v5
    v_fma_f32 v5, 2.0, v4, v5
    v_mul_f32 v125, s55, v5
    v_fma_f32 v5, 2.0, v4, v5
    v_mul_f32 v126, s55, v5
    v_fma_f32 v5, 2.0, v4, v5
    v_mul_f32 v127, s55, v5
    v_fract_f32 v120, v120
    v_fract_f32 v121, v121
    v_fract_f32 v122, v122
    v_fract_f32 v123, v123
    v_fract_f32 v124, v124
    v_fract_f32 v125, v125
    v_fract_f32 v126, v126
    v_fract_f32 v127, v127
    v_cos_f32 v128, v120
    v_cos_f32 v129, v121
    v_cos_f32 v130, v122
    v_cos_f32 v131, v123
    v_cos_f32 v132, v124
    v_cos_f32 v133, v125
    v_cos_f32 v134, v126
    v_cos_f32 v135, v127
    s_cmp_lg_u32 s58, 0
    s_cbranch_scc1 L_gen_plain_9
    v_mul_f32 v6, 0x3e800000, v4
    v_fract_f32 v6, v6
    v_cndmask_b32 v120, v120, v6, vcc
    v_cos_f32 v7, v6
    v_mov_b32 v161, 0
    v_mov_b32 v162, 0
    v_mov_b32 v163, 0
    v_cndmask_b32 v7, 0, v7, vcc
    v_cvt_pk_bf16_f32 v160, v7, 0
L_gen_plain_9:
    v_sin_f32 v120, v120
    v_sin_f32 v121, v121
    v_sin_f32 v122, v122
    v_sin_f32 v123, v123
    v_sin_f32 v124, v124
    v_sin_f32 v125, v125
    v_sin_f32 v126, v126
    v_sin_f32 v127, v127
    v_cvt_pk_bf16_f32 v64, v128, v129
    v_cvt_pk_bf16_f32 v65, v130, v131
    v_cvt_pk_bf16_f32 v66, v132, v133
    v_cvt_pk_bf16_f32 v67, v134, v135
    v_cvt_pk_bf16_f32 v68, v120, v121
    v_cvt_pk_bf16_f32 v69, v122, v123
    v_cvt_pk_bf16_f32 v70, v124, v125
    v_cvt_pk_bf16_f32 v71, v126, v127
    s_mov_b32 s51, s45
    s_mov_b32 s52, s46
L_sw_gen_done:
    s_branch L_fold_done
L_fold_go:
    s_cmp_lg_u32 s27, 0
    s_cselect_b32 s46, -1.0, 1.0
    s_mov_b32 s47, s46
    s_mov_b32 s48, 0xffff0000
    s_waitcnt vmcnt(8)
    v_lshlrev_b32 v112, 16, v32
    v_and_b32 v113, s48, v32
    v_lshlrev_b32 v20, 16, v36
    v_and_b32 v21, s48, v36
    v_pk_fma_f32 v[112:113], v[20:21], s[46:47], v[112:113]
    v_lshlrev_b32 v114, 16, v33
    v_and_b32 v115, s48, v33
    v_lshlrev_b32 v22, 16, v37
    v_and_b32 v23, s48, v37
    v_pk_fma_f32 v[114:115], v[22:23], s[46:47], v[114:115]
    v_lshlrev_b32 v116, 16, v34
    v_and_b32 v117, s48, v34
    v_lshlrev_b32 v20, 16, v38
    v_and_b32 v21, s48, v38
    v_pk_fma_f32 v[116:117], v[20:21], s[46:47], v[116:117]
    v_lshlrev_b32 v118, 16, v35
    v_and_b32 v119, s48, v35
    v_lshlrev_b32 v22, 16, v39
    v_and_b32 v23, s48, v39
    v_pk_fma_f32 v[118:119], v[22:23], s[46:47], v[118:119]
    v_lshlrev_b32 v120, 16, v40
    v_and_b32 v121, s48, v40
    v_lshlrev_b32 v20, 16, v44
    v_and_b32 v21, s48, v44
    v_pk_fma_f32 v[120:121], v[20:21], s[46:47], v[120:121]
    v_lshlrev_b32 v122, 16, v41
    v_and_b32 v123, s48, v41
    v_lshlrev_b32 v22, 16, v45
    v_and_b32 v23, s48, v45
    v_pk_fma_f32 v[122:123], v[22:23], s[46:47], v[122:123]
    v_lshlrev_b32 v124, 16, v42
    v_and_b32 v125, s48, v42
    v_lshlrev_b32 v20, 16, v46
    v_and_b32 v21, s48, v46
    v_pk_fma_f32 v[124:125], v[20:21], s[46:47], v[124:125]
    v_lshlrev_b32 v126, 16, v43
    v_and_b32 v127, s48, v43
    v_lshlrev_b32 v22, 16, v47
    v_and_b32 v23, s48, v47
    v_pk_fma_f32 v[126:127], v[22:23], s[46:47], v[126:127]
    v_lshlrev_b32 v128, 16, v48
    v_and_b32 v129, s48, v48
    v_lshlrev_b32 v20, 16, v52
    v_and_b32 v21, s48, v52
    v_pk_fma_f32 v[128:129], v[20:21], s[46:47], v[128:129]
    v_lshlrev_b32 v130, 16, v49
    v_and_b32 v131, s48, v49
    v_lshlrev_b32 v22, 16, v53
    v_and_b32 v23, s48, v53
    v_pk_fma_f32 v[130:131], v[22:23], s[46:47], v[130:131]
    v_lshlrev_b32 v132, 16, v50
    v_and_b32 v133, s48, v50
    v_lshlrev_b32 v20, 16, v54
    v_and_b32 v21, s48, v54
    v_pk_fma_f32 v[132:133], v[20:21], s[46:47], v[132:133]
    v_lshlrev_b32 v134, 16, v51
    v_and_b32 v135, s48, v51
    v_lshlrev_b32 v22, 16, v55
    v_and_b32 v23, s48, v55
    v_pk_fma_f32 v[134:135], v[22:23], s[46:47], v[134:135]
    v_lshlrev_b32 v136, 16, v56
    v_and_b32 v137, s48, v56
    v_lshlrev_b32 v20, 16, v60
    v_and_b32 v21, s48, v60
    v_pk_fma_f32 v[136:137], v[20:21], s[46:47], v[136:137]
    v_lshlrev_b32 v138, 16, v57
    v_and_b32 v139, s48, v57
    v_lshlrev_b32 v22, 16, v61
    v_and_b32 v23, s48, v61
    v_pk_fma_f32 v[138:139], v[22:23], s[46:47], v[138:139]
    v_lshlrev_b32 v140, 16, v58
    v_and_b32 v141, s48, v58
    v_lshlrev_b32 v20, 16, v62
    v_and_b32 v21, s48, v62
    v_pk_fma_f32 v[140:141], v[20:21], s[46:47], v[140:141]
    v_lshlrev_b32 v142, 16, v59
    v_and_b32 v143, s48, v59
    v_lshlrev_b32 v22, 16, v63
    v_and_b32 v23, s48, v63
    v_pk_fma_f32 v[142:143], v[22:23], s[46:47], v[142:143]
    v_pk_add_f32 v[144:145], v[112:113], v[120:121]
    v_pk_add_f32 v[152:153], v[112:113], v[120:121] neg_lo:[0,1] neg_hi:[0,1]
    v_pk_add_f32 v[160:161], v[128:129], v[136:137]
    v_pk_add_f32 v[168:169], v[128:129], v[136:137] neg_lo:[0,1] neg_hi:[0,1]
    v_pk_add_f32 v[112:113], v[144:145], v[160:161]
    v_pk_add_f32 v[120:121], v[144:145], v[160:161] neg_lo:[0,1] neg_hi:[0,1]
    v_pk_add_f32 v[128:129], v[152:153], v[168:169] neg_lo:[0,1] neg_hi:[0,1]
    v_pk_add_f32 v[136:137], v[152:153], v[168:169]
    v_pk_add_f32 v[146:147], v[114:115], v[122:123]
    v_pk_add_f32 v[154:155], v[114:115], v[122:123] neg_lo:[0,1] neg_hi:[0,1]
    v_pk_add_f32 v[162:163], v[130:131], v[138:139]
    v_pk_add_f32 v[170:171], v[130:131], v[138:139] neg_lo:[0,1] neg_hi:[0,1]
    v_pk_add_f32 v[114:115], v[146:147], v[162:163]
    v_pk_add_f32 v[122:123], v[146:147], v[162:163] neg_lo:[0,1] neg_hi:[0,1]
    v_pk_add_f32 v[130:131], v[154:155], v[170:171] neg_lo:[0,1] neg_hi:[0,1]
    v_pk_add_f32 v[138:139], v[154:155], v[170:171]
    v_pk_add_f32 v[148:149], v[116:117], v[124:125]
    v_pk_add_f32 v[156:157], v[116:117], v[124:125] neg_lo:[0,1] neg_hi:[0,1]
    v_pk_add_f32 v[164:165], v[132:133], v[140:141]
    v_pk_add_f32 v[172:173], v[132:133], v[140:141] neg_lo:[0,1] neg_hi:[0,1]
    v_pk_add_f32 v[116:117], v[148:149], v[164:165]
    v_pk_add_f32 v[124:125], v[148:149], v[164:165] neg_lo:[0,1] neg_hi:[0,1]
    v_pk_add_f32 v[132:133], v[156:157], v[172:173] neg_lo:[0,1] neg_hi:[0,1]
    v_pk_add_f32 v[140:141], v[156:157], v[172:173]
    v_pk_add_f32 v[150:151], v[118:119], v[126:127]
    v_pk_add_f32 v[158:159], v[118:119], v[126:127] neg_lo:[0,1] neg_hi:[0,1]
    v_pk_add_f32 v[166:167], v[134:135], v[142:143]
    v_pk_add_f32 v[174:175], v[134:135], v[142:143] neg_lo:[0,1] neg_hi:[0,1]
    v_pk_add_f32 v[118:119], v[150:151], v[166:167]
    v_pk_add_f32 v[126:127], v[150:151], v[166:167] neg_lo:[0,1] neg_hi:[0,1]
    v_pk_add_f32 v[134:135], v[158:159], v[174:175] neg_lo:[0,1] neg_hi:[0,1]
    v_pk_add_f32 v[142:143], v[158:159], v[174:175]
    s_cmp_lg_u32 s26, 0
    s_cbranch_scc1 L_fold_sp
    s_waitcnt vmcnt(0)
    v_lshlrev_b32 v144, 16, v96
    v_and_b32 v145, s48, v96
    v_lshlrev_b32 v20, 16, v100
    v_and_b32 v21, s48, v100
    v_pk_fma_f32 v[144:145], v[20:21], s[46:47], v[144:145]
    v_lshlrev_b32 v146, 16, v97
    v_and_b32 v147, s48, v97
    v_lshlrev_b32 v22, 16, v101
    v_and_b32 v23, s48, v101
    v_pk_fma_f32 v[146:147], v[22:23], s[46:47], v[146:147]
    v_lshlrev_b32 v148, 16, v98
    v_and_b32 v149, s48, v98
    v_lshlrev_b32 v20, 16, v102
    v_and_b32 v21, s48, v102
    v_pk_fma_f32 v[148:149], v[20:21], s[46:47], v[148:149]
    v_lshlrev_b32 v150, 16, v99
    v_and_b32 v151, s48, v99
    v_lshlrev_b32 v22, 16, v103
    v_and_b32 v23, s48, v103
    v_pk_fma_f32 v[150:151], v[22:23], s[46:47], v[150:151]
    v_lshlrev_b32 v152, 16, v104
    v_and_b32 v153, s48, v104
    v_lshlrev_b32 v20, 16, v108
    v_and_b32 v21, s48, v108
    v_pk_fma_f32 v[152:153], v[20:21], s[46:47], v[152:153]
    v_lshlrev_b32 v154, 16, v105
    v_and_b32 v155, s48, v105
    v_lshlrev_b32 v22, 16, v109
    v_and_b32 v23, s48, v109
    v_pk_fma_f32 v[154:155], v[22:23], s[46:47], v[154:155]
    v_lshlrev_b32 v156, 16, v106
    v_and_b32 v157, s48, v106
    v_lshlrev_b32 v20, 16, v110
    v_and_b32 v21, s48, v110
    v_pk_fma_f32 v[156:157], v[20:21], s[46:47], v[156:157]
    v_lshlrev_b32 v158, 16, v107
    v_and_b32 v159, s48, v107
    v_lshlrev_b32 v22, 16, v111
    v_and_b32 v23, s48, v111
    v_pk_fma_f32 v[158:159], v[22:23], s[46:47], v[158:159]
    v_pk_add_f32 v[160:161], v[144:145], v[152:153]
    v_pk_add_f32 v[144:145], v[144:145], v[152:153] neg_lo:[0,1] neg_hi:[0,1]
    v_pk_add_f32 v[162:163], v[146:147], v[154:155]
    v_pk_add_f32 v[146:147], v[146:147], v[154:155] neg_lo:[0,1] neg_hi:[0,1]
    v_pk_add_f32 v[164:165], v[148:149], v[156:157]
    v_pk_add_f32 v[148:149], v[148:149], v[156:157] neg_lo:[0,1] neg_hi:[0,1]
    v_pk_add_f32 v[166:167], v[150:151], v[158:159]
    v_pk_add_f32 v[150:151], v[150:151], v[158:159] neg_lo:[0,1] neg_hi:[0,1]
    v_cndmask_b32 v136, v144, v136, vcc
    v_cndmask_b32 v137, v145, v137, vcc
    v_cndmask_b32 v138, v146, v138, vcc
    v_cndmask_b32 v139, v147, v139, vcc
    v_cndmask_b32 v140, v148, v140, vcc
    v_cndmask_b32 v141, v149, v141, vcc
    v_cndmask_b32 v142, v150, v142, vcc
    v_cndmask_b32 v143, v151, v143, vcc
    v_cvt_pk_bf16_f32 v144, v160, v161
    v_cvt_pk_bf16_f32 v145, v162, v163
    v_cvt_pk_bf16_f32 v146, v164, v165
    v_cvt_pk_bf16_f32 v147, v166, v167
    ds_write_b128 v17, v[144:147]
L_fold_sp:
    v_cvt_pk_bf16_f32 v32, v112, v113
    v_cvt_pk_bf16_f32 v33, v114, v115
    v_cvt_pk_bf16_f32 v34, v116, v117
    v_cvt_pk_bf16_f32 v35, v118, v119
    ds_write_b128 v16, v[32:35] offset:0
    v_cvt_pk_bf16_f32 v36, v120, v121
    v_cvt_pk_bf16_f32 v37, v122, v123
    v_cvt_pk_bf16_f32 v38, v124, v125
    v_cvt_pk_bf16_f32 v39, v126, v127
    ds_write_b128 v16, v[36:39] offset:256
    v_cvt_pk_bf16_f32 v40, v128, v129
    v_cvt_pk_bf16_f32 v41, v130, v131
    v_cvt_pk_bf16_f32 v42, v132, v133
    v_cvt_pk_bf16_f32 v43, v134, v135
    ds_write_b128 v16, v[40:43] offset:20480
    v_cvt_pk_bf16_f32 v44, v136, v137
    v_cvt_pk_bf16_f32 v45, v138, v139
    v_cvt_pk_bf16_f32 v46, v140, v141
    v_cvt_pk_bf16_f32 v47, v142, v143
    ds_write_b128 v16, v[44:47] offset:20736
    s_waitcnt vmcnt(0)
    v_lshlrev_b32 v112, 16, v64
    v_and_b32 v113, s48, v64
    v_lshlrev_b32 v20, 16, v68
    v_and_b32 v21, s48, v68
    v_pk_fma_f32 v[112:113], v[20:21], s[46:47], v[112:113]
    v_lshlrev_b32 v114, 16, v65
    v_and_b32 v115, s48, v65
    v_lshlrev_b32 v22, 16, v69
    v_and_b32 v23, s48, v69
    v_pk_fma_f32 v[114:115], v[22:23], s[46:47], v[114:115]
    v_lshlrev_b32 v116, 16, v66
    v_and_b32 v117, s48, v66
    v_lshlrev_b32 v20, 16, v70
    v_and_b32 v21, s48, v70
    v_pk_fma_f32 v[116:117], v[20:21], s[46:47], v[116:117]
    v_lshlrev_b32 v118, 16, v67
    v_and_b32 v119, s48, v67
    v_lshlrev_b32 v22, 16, v71
    v_and_b32 v23, s48, v71
    v_pk_fma_f32 v[118:119], v[22:23], s[46:47], v[118:119]
    v_lshlrev_b32 v120, 16, v72
    v_and_b32 v121, s48, v72
    v_lshlrev_b32 v20, 16, v76
    v_and_b32 v21, s48, v76
    v_pk_fma_f32 v[120:121], v[20:21], s[46:47], v[120:121]
    v_lshlrev_b32 v122, 16, v73
    v_and_b32 v123, s48, v73
    v_lshlrev_b32 v22, 16, v77
    v_and_b32 v23, s48, v77
    v_pk_fma_f32 v[122:123], v[22:23], s[46:47], v[122:123]
    v_lshlrev_b32 v124, 16, v74
    v_and_b32 v125, s48, v74
    v_lshlrev_b32 v20, 16, v78
    v_and_b32 v21, s48, v78
    v_pk_fma_f32 v[124:125], v[20:21], s[46:47], v[124:125]
    v_lshlrev_b32 v126, 16, v75
    v_and_b32 v127, s48, v75
    v_lshlrev_b32 v22, 16, v79
    v_and_b32 v23, s48, v79
    v_pk_fma_f32 v[126:127], v[22:23], s[46:47], v[126:127]
    v_lshlrev_b32 v128, 16, v80
    v_and_b32 v129, s48, v80
    v_lshlrev_b32 v20, 16, v84
    v_and_b32 v21, s48, v84
    v_pk_fma_f32 v[128:129], v[20:21], s[46:47], v[128:129]
    v_lshlrev_b32 v130, 16, v81
    v_and_b32 v131, s48, v81
    v_lshlrev_b32 v22, 16, v85
    v_and_b32 v23, s48, v85
    v_pk_fma_f32 v[130:131], v[22:23], s[46:47], v[130:131]
    v_lshlrev_b32 v132, 16, v82
    v_and_b32 v133, s48, v82
    v_lshlrev_b32 v20, 16, v86
    v_and_b32 v21, s48, v86
    v_pk_fma_f32 v[132:133], v[20:21], s[46:47], v[132:133]
    v_lshlrev_b32 v134, 16, v83
    v_and_b32 v135, s48, v83
    v_lshlrev_b32 v22, 16, v87
    v_and_b32 v23, s48, v87
    v_pk_fma_f32 v[134:135], v[22:23], s[46:47], v[134:135]
    v_lshlrev_b32 v136, 16, v88
    v_and_b32 v137, s48, v88
    v_lshlrev_b32 v20, 16, v92
    v_and_b32 v21, s48, v92
    v_pk_fma_f32 v[136:137], v[20:21], s[46:47], v[136:137]
    v_lshlrev_b32 v138, 16, v89
    v_and_b32 v139, s48, v89
    v_lshlrev_b32 v22, 16, v93
    v_and_b32 v23, s48, v93
    v_pk_fma_f32 v[138:139], v[22:23], s[46:47], v[138:139]
    v_lshlrev_b32 v140, 16, v90
    v_and_b32 v141, s48, v90
    v_lshlrev_b32 v20, 16, v94
    v_and_b32 v21, s48, v94
    v_pk_fma_f32 v[140:141], v[20:21], s[46:47], v[140:141]
    v_lshlrev_b32 v142, 16, v91
    v_and_b32 v143, s48, v91
    v_lshlrev_b32 v22, 16, v95
    v_and_b32 v23, s48, v95
    v_pk_fma_f32 v[142:143], v[22:23], s[46:47], v[142:143]
    v_pk_add_f32 v[144:145], v[112:113], v[120:121]
    v_pk_add_f32 v[152:153], v[112:113], v[120:121] neg_lo:[0,1] neg_hi:[0,1]
    v_pk_add_f32 v[160:161], v[128:129], v[136:137]
    v_pk_add_f32 v[168:169], v[128:129], v[136:137] neg_lo:[0,1] neg_hi:[0,1]
    v_pk_add_f32 v[112:113], v[144:145], v[160:161]
    v_pk_add_f32 v[120:121], v[144:145], v[160:161] neg_lo:[0,1] neg_hi:[0,1]
    v_pk_add_f32 v[128:129], v[152:153], v[168:169] neg_lo:[0,1] neg_hi:[0,1]
    v_pk_add_f32 v[136:137], v[152:153], v[168:169]
    v_pk_add_f32 v[146:147], v[114:115], v[122:123]
    v_pk_add_f32 v[154:155], v[114:115], v[122:123] neg_lo:[0,1] neg_hi:[0,1]
    v_pk_add_f32 v[162:163], v[130:131], v[138:139]
    v_pk_add_f32 v[170:171], v[130:131], v[138:139] neg_lo:[0,1] neg_hi:[0,1]
    v_pk_add_f32 v[114:115], v[146:147], v[162:163]
    v_pk_add_f32 v[122:123], v[146:147], v[162:163] neg_lo:[0,1] neg_hi:[0,1]
    v_pk_add_f32 v[130:131], v[154:155], v[170:171] neg_lo:[0,1] neg_hi:[0,1]
    v_pk_add_f32 v[138:139], v[154:155], v[170:171]
    v_pk_add_f32 v[148:149], v[116:117], v[124:125]
    v_pk_add_f32 v[156:157], v[116:117], v[124:125] neg_lo:[0,1] neg_hi:[0,1]
    v_pk_add_f32 v[164:165], v[132:133], v[140:141]
    v_pk_add_f32 v[172:173], v[132:133], v[140:141] neg_lo:[0,1] neg_hi:[0,1]
    v_pk_add_f32 v[116:117], v[148:149], v[164:165]
    v_pk_add_f32 v[124:125], v[148:149], v[164:165] neg_lo:[0,1] neg_hi:[0,1]
    v_pk_add_f32 v[132:133], v[156:157], v[172:173] neg_lo:[0,1] neg_hi:[0,1]
    v_pk_add_f32 v[140:141], v[156:157], v[172:173]
    v_pk_add_f32 v[150:151], v[118:119], v[126:127]
    v_pk_add_f32 v[158:159], v[118:119], v[126:127] neg_lo:[0,1] neg_hi:[0,1]
    v_pk_add_f32 v[166:167], v[134:135], v[142:143]
    v_pk_add_f32 v[174:175], v[134:135], v[142:143] neg_lo:[0,1] neg_hi:[0,1]
    v_pk_add_f32 v[118:119], v[150:151], v[166:167]
    v_pk_add_f32 v[126:127], v[150:151], v[166:167] neg_lo:[0,1] neg_hi:[0,1]
    v_pk_add_f32 v[134:135], v[158:159], v[174:175] neg_lo:[0,1] neg_hi:[0,1]
    v_pk_add_f32 v[142:143], v[158:159], v[174:175]
    v_cvt_pk_bf16_f32 v64, v112, v113
    v_cvt_pk_bf16_f32 v65, v114, v115
    v_cvt_pk_bf16_f32 v66, v116, v117
    v_cvt_pk_bf16_f32 v67, v118, v119
    ds_write_b128 v18, v[64:67] offset:0
    v_cvt_pk_bf16_f32 v68, v120, v121
    v_cvt_pk_bf16_f32 v69, v122, v123
    v_cvt_pk_bf16_f32 v70, v124, v125
    v_cvt_pk_bf16_f32 v71, v126, v127
    ds_write_b128 v18, v[68:71] offset:256
    v_cvt_pk_bf16_f32 v72, v128, v129
    v_cvt_pk_bf16_f32 v73, v130, v131
    v_cvt_pk_bf16_f32 v74, v132, v133
    v_cvt_pk_bf16_f32 v75, v134, v135
    ds_write_b128 v18, v[72:75] offset:20480
    v_cvt_pk_bf16_f32 v76, v136, v137
    v_cvt_pk_bf16_f32 v77, v138, v139
    v_cvt_pk_bf16_f32 v78, v140, v141
    v_cvt_pk_bf16_f32 v79, v142, v143
    ds_write_b128 v18, v[76:79] offset:20736
L_fold_done:
    v_mov_b32 v32, 0
    v_mov_b32 v33, 0
    v_mov_b32 v34, 0
    v_mov_b32 v35, 0
    v_mov_b32 v36, 0
    v_mov_b32 v37, 0
    v_mov_b32 v38, 0
    v_mov_b32 v39, 0
    v_mov_b32 v40, 0
    v_mov_b32 v41, 0
    v_mov_b32 v42, 0
    v_mov_b32 v43, 0
    v_mov_b32 v44, 0
    v_mov_b32 v45, 0
    v_mov_b32 v46, 0
    v_mov_b32 v47, 0
    s_waitcnt lgkmcnt(0)
    s_barrier
    s_cmp_lt_u32 s3, 5
    s_cbranch_scc1 L_no_side
    s_sub_u32 s53, s2, 192
    s_mul_i32 s53, s53, 3
    s_add_u32 s53, s53, s3
    s_sub_u32 s53, s53, 5
    s_mov_b32 s32, s8
    s_mov_b32 s33, s9
    s_mov_b32 s34, 819200
    s_mov_b32 s35, 0x00020000
    s_add_u32 s28, s16, 10485760
    s_addc_u32 s29, s17, 0
    s_mov_b32 s30, 3437568
    s_mov_b32 s31, 0x00020000
    buffer_store_dwordx4 v[48:51], v15, s[28:31], s40 offen sc1
    buffer_store_dwordx4 v[52:55], v15, s[28:31], s42 offen sc1
    s_and_b32 s41, s53, 31
    s_cbranch_scc1 L_sw_nx_10
    s_add_u32 s41, s40, 16384
    buffer_store_dwordx4 v[24:27], v15, s[28:31], s41 offen sc1
L_sw_nx_10:
    buffer_store_dwordx4 v[56:59], v15, s[28:31], s43 offen sc1
    buffer_store_dwordx4 v[60:63], v15, s[28:31], s44 offen sc1
    s_and_b32 s41, s53, 31
    s_cbranch_scc1 L_sw_nx_11
    s_add_u32 s41, s43, 16384
    buffer_store_dwordx4 v[28:31], v15, s[28:31], s41 offen sc1
L_sw_nx_11:
    s_cmp_ge_u32 s53, 160
    s_cbranch_scc1 L_sw_st_done
    buffer_store_dwordx4 v[64:67], v15, s[28:31], s51 offen sc1
    buffer_store_dwordx4 v[68:71], v15, s[28:31], s52 offen sc1
    s_and_b32 s41, s53, 31
    s_cbranch_scc1 L_sw_nx_12
    s_add_u32 s41, s51, 16384
    buffer_store_dwordx4 v[160:163], v15, s[28:31], s41 offen sc1
L_sw_nx_12:
L_sw_st_done:
    s_add_u32 s40, s53, 0
    s_mul_i32 s41, s40, 1639
    s_lshr_b32 s41, s41, 16
    s_mul_i32 s58, s41, 40
    s_sub_u32 s58, s40, s58
    s_mul_i32 s59, s58, 20
    s_mul_i32 s55, s58, 80
    s_sub_u32 s55, s55, 2544
    s_cmp_lt_u32 s58, 32
    s_cselect_b32 s45, 4, 40
    s_cselect_b32 s59, s59, s55
    s_mov_b32 s46, 25600
    s_cmov_b32 s46, 10240
    v_mul_u32_u24 v4, s45, v3
    v_add_u32 v4, s59, v4
    v_mul_u32_u24 v4, 1280, v4
    s_lshl_b32 s59, s41, 6
    v_lshl_add_u32 v4, v2, 1, v4
    v_add_u32 v4, s59, v4
    buffer_load_ushort v120, v4, s[32:35], 0 offen offset:0
    buffer_load_ushort v121, v4, s[32:35], 0 offen offset:1280
    buffer_load_ushort v122, v4, s[32:35], 0 offen offset:2560
    buffer_load_ushort v123, v4, s[32:35], 0 offen offset:3840
    buffer_load_ushort v124, v4, s[32:35], s46 offen offset:0
    buffer_load_ushort v125, v4, s[32:35], s46 offen offset:1280
    buffer_load_ushort v126, v4, s[32:35], s46 offen offset:2560
    buffer_load_ushort v127, v4, s[32:35], s46 offen offset:3840
    s_mul_i32 s59, s41, 52
    s_lshr_b32 s59, s59, 8
    s_mul_i32 s55, s59, 5
    s_sub_u32 s55, s41, s55
    s_mul_i32 s45, s58, 26
    s_lshr_b32 s45, s45, 8
    s_mul_i32 s47, s45, 10
    s_sub_u32 s47, s58, s47
    s_add_u32 s58, s58, 10
    s_cmp_lt_u32 s55, 4
    s_cselect_b32 s55, s55, s45
    s_cselect_b32 s58, s58, s47
    s_lshl_b32 s59, s59, 2
    s_add_u32 s59, s59, s55
    s_mul_i32 s59, s59, 50
    s_add_u32 s59, s59, s58
    s_lshl_b32 s59, s59, 10
    s_add_u32 s56, s59, 2618368
    s_add_u32 s40, s53, 192
    s_mul_i32 s41, s40, 1639
    s_lshr_b32 s41, s41, 16
    s_mul_i32 s58, s41, 40
    s_sub_u32 s58, s40, s58
    s_mul_i32 s59, s58, 20
    s_mul_i32 s55, s58, 80
    s_sub_u32 s55, s55, 2544
    s_cmp_lt_u32 s58, 32
    s_cselect_b32 s45, 4, 40
    s_cselect_b32 s59, s59, s55
    s_mov_b32 s46, 25600
    s_cmov_b32 s46, 10240
    v_mul_u32_u24 v4, s45, v3
    v_add_u32 v4, s59, v4
    v_mul_u32_u24 v4, 1280, v4
    s_lshl_b32 s59, s41, 6
    v_lshl_add_u32 v4, v2, 1, v4
    v_add_u32 v4, s59, v4
    buffer_load_ushort v128, v4, s[32:35], 0 offen offset:0
    buffer_load_ushort v129, v4, s[32:35], 0 offen offset:1280
    buffer_load_ushort v130, v4, s[32:35], 0 offen offset:2560
    buffer_load_ushort v131, v4, s[32:35], 0 offen offset:3840
    buffer_load_ushort v132, v4, s[32:35], s46 offen offset:0
    buffer_load_ushort v133, v4, s[32:35], s46 offen offset:1280
    buffer_load_ushort v134, v4, s[32:35], s46 offen offset:2560
    buffer_load_ushort v135, v4, s[32:35], s46 offen offset:3840
    s_mul_i32 s59, s41, 52
    s_lshr_b32 s59, s59, 8
    s_mul_i32 s55, s59, 5
    s_sub_u32 s55, s41, s55
    s_mul_i32 s45, s58, 26
    s_lshr_b32 s45, s45, 8
    s_mul_i32 s47, s45, 10
    s_sub_u32 s47, s58, s47
    s_add_u32 s58, s58, 10
    s_cmp_lt_u32 s55, 4
    s_cselect_b32 s55, s55, s45
    s_cselect_b32 s58, s58, s47
    s_lshl_b32 s59, s59, 2
    s_add_u32 s59, s59, s55
    s_mul_i32 s59, s59, 50
    s_add_u32 s59, s59, s58
    s_lshl_b32 s59, s59, 10
    s_add_u32 s57, s59, 2618368
    s_add_u32 s40, s53, 384
    s_mul_i32 s41, s40, 1639
    s_lshr_b32 s41, s41, 16
    s_mul_i32 s58, s41, 40
    s_sub_u32 s58, s40, s58
    s_mul_i32 s59, s58, 20
    s_mul_i32 s55, s58, 80
    s_sub_u32 s55, s55, 2544
    s_cmp_lt_u32 s58, 32
    s_cselect_b32 s45, 4, 40
    s_cselect_b32 s59, s59, s55
    s_mov_b32 s46, 25600
    s_cmov_b32 s46, 10240
    v_mul_u32_u24 v4, s45, v3
    v_add_u32 v4, s59, v4
    v_mul_u32_u24 v4, 1280, v4
    s_lshl_b32 s59, s41, 6
    v_lshl_add_u32 v4, v2, 1, v4
    v_add_u32 v4, s59, v4
    buffer_load_ushort v136, v4, s[32:35], 0 offen offset:0
    buffer_load_ushort v137, v4, s[32:35], 0 offen offset:1280
    buffer_load_ushort v138, v4, s[32:35], 0 offen offset:2560
    buffer_load_ushort v139, v4, s[32:35], 0 offen offset:3840
    buffer_load_ushort v140, v4, s[32:35], s46 offen offset:0
    buffer_load_ushort v141, v4, s[32:35], s46 offen offset:1280
    buffer_load_ushort v142, v4, s[32:35], s46 offen offset:2560
    buffer_load_ushort v143, v4, s[32:35], s46 offen offset:3840
    s_mul_i32 s59, s41, 52
    s_lshr_b32 s59, s59, 8
    s_mul_i32 s55, s59, 5
    s_sub_u32 s55, s41, s55
    s_mul_i32 s45, s58, 26
    s_lshr_b32 s45, s45, 8
    s_mul_i32 s47, s45, 10
    s_sub_u32 s47, s58, s47
    s_add_u32 s58, s58, 10
    s_cmp_lt_u32 s55, 4
    s_cselect_b32 s55, s55, s45
    s_cselect_b32 s58, s58, s47
    s_lshl_b32 s59, s59, 2
    s_add_u32 s59, s59, s55
    s_mul_i32 s59, s59, 50
    s_add_u32 s59, s59, s58
    s_lshl_b32 s59, s59, 10
    s_add_u32 s96, s59, 2618368
    s_add_u32 s40, s53, 576
    s_mul_i32 s41, s40, 1639
    s_lshr_b32 s41, s41, 16
    s_mul_i32 s58, s41, 40
    s_sub_u32 s58, s40, s58
    s_mul_i32 s59, s58, 20
    s_mul_i32 s55, s58, 80
    s_sub_u32 s55, s55, 2544
    s_cmp_lt_u32 s58, 32
    s_cselect_b32 s45, 4, 40
    s_cselect_b32 s59, s59, s55
    s_mov_b32 s46, 25600
    s_cmov_b32 s46, 10240
    v_mul_u32_u24 v4, s45, v3
    v_add_u32 v4, s59, v4
    v_mul_u32_u24 v4, 1280, v4
    s_lshl_b32 s59, s41, 6
    v_lshl_add_u32 v4, v2, 1, v4
    v_add_u32 v4, s59, v4
    buffer_load_ushort v144, v4, s[32:35], 0 offen offset:0
    buffer_load_ushort v145, v4, s[32:35], 0 offen offset:1280
    buffer_load_ushort v146, v4, s[32:35], 0 offen offset:2560
    buffer_load_ushort v147, v4, s[32:35], 0 offen offset:3840
    buffer_load_ushort v148, v4, s[32:35], s46 offen offset:0
    buffer_load_ushort v149, v4, s[32:35], s46 offen offset:1280
    buffer_load_ushort v150, v4, s[32:35], s46 offen offset:2560
    buffer_load_ushort v151, v4, s[32:35], s46 offen offset:3840
    s_mul_i32 s59, s41, 52
    s_lshr_b32 s59, s59, 8
    s_mul_i32 s55, s59, 5
    s_sub_u32 s55, s41, s55
    s_mul_i32 s45, s58, 26
    s_lshr_b32 s45, s45, 8
    s_mul_i32 s47, s45, 10
    s_sub_u32 s47, s58, s47
    s_add_u32 s58, s58, 10
    s_cmp_lt_u32 s55, 4
    s_cselect_b32 s55, s55, s45
    s_cselect_b32 s58, s58, s47
    s_lshl_b32 s59, s59, 2
    s_add_u32 s59, s59, s55
    s_mul_i32 s59, s59, 50
    s_add_u32 s59, s59, s58
    s_lshl_b32 s59, s59, 10
    s_add_u32 s97, s59, 2618368
    s_cmp_ge_u32 s53, 32
    s_cbranch_scc1 L_sw_wo_ld
    s_add_u32 s40, s53, 768
    s_mul_i32 s41, s40, 1639
    s_lshr_b32 s41, s41, 16
    s_mul_i32 s58, s41, 40
    s_sub_u32 s58, s40, s58
    s_mul_i32 s59, s58, 20
    s_mul_i32 s55, s58, 80
    s_sub_u32 s55, s55, 2544
    s_cmp_lt_u32 s58, 32
    s_cselect_b32 s45, 4, 40
    s_cselect_b32 s59, s59, s55
    s_mov_b32 s46, 25600
    s_cmov_b32 s46, 10240
    v_mul_u32_u24 v4, s45, v3
    v_add_u32 v4, s59, v4
    v_mul_u32_u24 v4, 1280, v4
    s_lshl_b32 s59, s41, 6
    v_lshl_add_u32 v4, v2, 1, v4
    v_add_u32 v4, s59, v4
    buffer_load_ushort v152, v4, s[32:35], 0 offen offset:0
    buffer_load_ushort v153, v4, s[32:35], 0 offen offset:1280
    buffer_load_ushort v154, v4, s[32:35], 0 offen offset:2560
    buffer_load_ushort v155, v4, s[32:35], 0 offen offset:3840
    buffer_load_ushort v156, v4, s[32:35], s46 offen offset:0
    buffer_load_ushort v157, v4, s[32:35], s46 offen offset:1280
    buffer_load_ushort v158, v4, s[32:35], s46 offen offset:2560
    buffer_load_ushort v159, v4, s[32:35], s46 offen offset:3840
    s_mul_i32 s59, s41, 52
    s_lshr_b32 s59, s59, 8
    s_mul_i32 s55, s59, 5
    s_sub_u32 s55, s41, s55
    s_mul_i32 s45, s58, 26
    s_lshr_b32 s45, s45, 8
    s_mul_i32 s47, s45, 10
    s_sub_u32 s47, s58, s47
    s_add_u32 s58, s58, 10
    s_cmp_lt_u32 s55, 4
    s_cselect_b32 s55, s55, s45
    s_cselect_b32 s58, s58, s47
    s_lshl_b32 s59, s59, 2
    s_add_u32 s59, s59, s55
    s_mul_i32 s59, s59, 50
    s_add_u32 s59, s59, s58
    s_lshl_b32 s59, s59, 10
    s_add_u32 s100, s59, 2618368
L_sw_wo_ld:
L_no_side:
    s_mov_b32 s28, s14
    s_mov_b32 s29, s15
    s_mov_b32 s30, 256
    s_mov_b32 s31, 0x00020000
    v_mov_b32 v16, 0
    buffer_load_dwordx2 v[4:5], v16, s[28:31], 0 offen sc1
    s_mul_i32 s42, s27, 6
    s_add_u32 s42, s42, s49
    s_cmp_gt_u32 s42, 10
    s_cbranch_scc0 L_f1_go
    s_waitcnt vmcnt(0)
    s_branch L_prep_done
L_f1_go:
    s_mov_b32 s45, 5
    s_or_b32 s51, s26, s50
    s_cmp_eq_u32 s51, 0
    s_cselect_b32 s40, 1, 0
    s_cmp_lt_u32 s3, 4
    s_cselect_b32 s41, 2, 0
    s_add_u32 s40, s40, s41
    s_cmp_eq_u32 s40, 1
    s_cbranch_scc1 L_f1_v1
    s_cmp_eq_u32 s40, 2
    s_cbranch_scc1 L_f1_v2
    s_cmp_eq_u32 s40, 3
    s_cbranch_scc1 L_f1_v3
L_f1_v0:
    ds_read_b128 v[72:75], v10 offset:0
    ds_read_b128 v[84:87], v11 offset:0
L_f1_loop0:
    s_waitcnt lgkmcnt(1)
    s_nop 0
    v_mfma_f32_32x32x16_bf16 v[224:239], v[72:75], v[208:211], v[224:239]
    ds_read_b128 v[96:99], v12 offset:0
    v_fma_f32 v184, v19, v176, -v184
    v_fma_f32 v185, v19, v177, -v185
    v_fma_f32 v186, v19, v178, -v186
    v_fma_f32 v187, v19, v179, -v187
    v_fma_f32 v188, v19, v180, -v188
    v_fma_f32 v189, v19, v181, -v189
    v_fma_f32 v190, v19, v182, -v190
    v_fma_f32 v191, v19, v183, -v191
    v_cvt_pk_bf16_f32 v212, v184, v185
    v_cvt_pk_bf16_f32 v213, v186, v187
    v_cvt_pk_bf16_f32 v214, v188, v189
    v_cvt_pk_bf16_f32 v215, v190, v191
    s_waitcnt lgkmcnt(1)
    s_nop 0
    v_mfma_f32_32x32x16_bf16 v[224:239], v[84:87], v[212:215], v[224:239]
    ds_read_b128 v[108:111], v13 offset:0
    v_fma_f32 v176, v19, v184, -v176
    v_fma_f32 v177, v19, v185, -v177
    v_fma_f32 v178, v19, v186, -v178
    v_fma_f32 v179, v19, v187, -v179
    v_fma_f32 v180, v19, v188, -v180
    v_fma_f32 v181, v19, v189, -v181
    v_fma_f32 v182, v19, v190, -v182
    v_fma_f32 v183, v19, v191, -v183
    v_cvt_pk_bf16_f32 v208, v176, v177
    v_cvt_pk_bf16_f32 v209, v178, v179
    v_cvt_pk_bf16_f32 v210, v180, v181
    v_cvt_pk_bf16_f32 v211, v182, v183
    s_waitcnt lgkmcnt(1)
    s_nop 0
    v_mfma_f32_32x32x16_bf16 v[224:239], v[96:99], v[208:211], v[224:239]
    ds_read_b128 v[72:75], v10 offset:4096
    v_fma_f32 v184, v19, v176, -v184
    v_fma_f32 v185, v19, v177, -v185
    v_fma_f32 v186, v19, v178, -v186
    v_fma_f32 v187, v19, v179, -v187
    v_fma_f32 v188, v19, v180, -v188
    v_fma_f32 v189, v19, v181, -v189
    v_fma_f32 v190, v19, v182, -v190
    v_fma_f32 v191, v19, v183, -v191
    v_cvt_pk_bf16_f32 v212, v184, v185
    v_cvt_pk_bf16_f32 v213, v186, v187
    v_cvt_pk_bf16_f32 v214, v188, v189
    v_cvt_pk_bf16_f32 v215, v190, v191
    s_waitcnt lgkmcnt(1)
    s_nop 0
    v_mfma_f32_32x32x16_bf16 v[224:239], v[108:111], v[212:215], v[224:239]
    ds_read_b128 v[84:87], v11 offset:4096
    v_fma_f32 v176, v19, v184, -v176
    v_fma_f32 v177, v19, v185, -v177
    v_fma_f32 v178, v19, v186, -v178
    v_fma_f32 v179, v19, v187, -v179
    v_fma_f32 v180, v19, v188, -v180
    v_fma_f32 v181, v19, v189, -v181
    v_fma_f32 v182, v19, v190, -v182
    v_fma_f32 v183, v19, v191, -v183
    v_cvt_pk_bf16_f32 v208, v176, v177
    v_cvt_pk_bf16_f32 v209, v178, v179
    v_cvt_pk_bf16_f32 v210, v180, v181
    v_cvt_pk_bf16_f32 v211, v182, v183
    v_add_u32 v10, 4096, v10
    v_add_u32 v11, 4096, v11
    v_add_u32 v12, 4096, v12
    v_add_u32 v13, 4096, v13
    s_sub_u32 s45, s45, 1
    s_cmp_lg_u32 s45, 0
    s_cbranch_scc1 L_f1_loop0
    s_branch L_f1_done
L_f1_v1:
    ds_read_b128 v[72:75], v10 offset:0
    ds_read_b128 v[80:83], v14 offset:0
    ds_read_b128 v[84:87], v11 offset:0
    ds_read_b128 v[92:95], v14 offset:32
L_f1_loop1:
    s_waitcnt lgkmcnt(2)
    s_nop 0
    v_mfma_f32_32x32x16_bf16 v[224:239], v[72:75], v[208:211], v[224:239]
    ds_read_b128 v[96:99], v12 offset:0
    v_fma_f32 v184, v19, v176, -v184
    v_fma_f32 v185, v19, v177, -v185
    v_fma_f32 v186, v19, v178, -v186
    v_fma_f32 v187, v19, v179, -v187
    v_fma_f32 v188, v19, v180, -v188
    v_fma_f32 v189, v19, v181, -v189
    v_mfma_f32_32x32x16_bf16 v[32:47], v[80:83], v[208:211], v[32:47]
    ds_read_b128 v[104:107], v14 offset:64
    v_fma_f32 v190, v19, v182, -v190
    v_fma_f32 v191, v19, v183, -v191
    v_cvt_pk_bf16_f32 v212, v184, v185
    v_cvt_pk_bf16_f32 v213, v186, v187
    v_cvt_pk_bf16_f32 v214, v188, v189
    v_cvt_pk_bf16_f32 v215, v190, v191
    s_waitcnt lgkmcnt(2)
    s_nop 0
    v_mfma_f32_32x32x16_bf16 v[224:239], v[84:87], v[212:215], v[224:239]
    ds_read_b128 v[108:111], v13 offset:0
    v_fma_f32 v176, v19, v184, -v176
    v_fma_f32 v177, v19, v185, -v177
    v_fma_f32 v178, v19, v186, -v178
    v_fma_f32 v179, v19, v187, -v179
    v_fma_f32 v180, v19, v188, -v180
    v_fma_f32 v181, v19, v189, -v181
    v_mfma_f32_32x32x16_bf16 v[32:47], v[92:95], v[212:215], v[32:47]
    ds_read_b128 v[116:119], v14 offset:96
    v_fma_f32 v182, v19, v190, -v182
    v_fma_f32 v183, v19, v191, -v183
    v_cvt_pk_bf16_f32 v208, v176, v177
    v_cvt_pk_bf16_f32 v209, v178, v179
    v_cvt_pk_bf16_f32 v210, v180, v181
    v_cvt_pk_bf16_f32 v211, v182, v183
    s_waitcnt lgkmcnt(2)
    s_nop 0
    v_mfma_f32_32x32x16_bf16 v[224:239], v[96:99], v[208:211], v[224:239]
    ds_read_b128 v[72:75], v10 offset:4096
    v_fma_f32 v184, v19, v176, -v184
    v_fma_f32 v185, v19, v177, -v185
    v_fma_f32 v186, v19, v178, -v186
    v_fma_f32 v187, v19, v179, -v187
    v_fma_f32 v188, v19, v180, -v188
    v_fma_f32 v189, v19, v181, -v189
    v_mfma_f32_32x32x16_bf16 v[32:47], v[104:107], v[208:211], v[32:47]
    ds_read_b128 v[80:83], v14 offset:128
    v_fma_f32 v190, v19, v182, -v190
    v_fma_f32 v191, v19, v183, -v191
    v_cvt_pk_bf16_f32 v212, v184, v185
    v_cvt_pk_bf16_f32 v213, v186, v187
    v_cvt_pk_bf16_f32 v214, v188, v189
    v_cvt_pk_bf16_f32 v215, v190, v191
    s_waitcnt lgkmcnt(2)
    s_nop 0
    v_mfma_f32_32x32x16_bf16 v[224:239], v[108:111], v[212:215], v[224:239]
    ds_read_b128 v[84:87], v11 offset:4096
    v_fma_f32 v176, v19, v184, -v176
    v_fma_f32 v177, v19, v185, -v177
    v_fma_f32 v178, v19, v186, -v178
    v_fma_f32 v179, v19, v187, -v179
    v_fma_f32 v180, v19, v188, -v180
    v_fma_f32 v181, v19, v189, -v181
    v_mfma_f32_32x32x16_bf16 v[32:47], v[116:119], v[212:215], v[32:47]
    ds_read_b128 v[92:95], v14 offset:160
    v_fma_f32 v182, v19, v190, -v182
    v_fma_f32 v183, v19, v191, -v183
    v_cvt_pk_bf16_f32 v208, v176, v177
    v_cvt_pk_bf16_f32 v209, v178, v179
    v_cvt_pk_bf16_f32 v210, v180, v181
    v_cvt_pk_bf16_f32 v211, v182, v183
    v_add_u32 v10, 4096, v10
    v_add_u32 v11, 4096, v11
    v_add_u32 v12, 4096, v12
    v_add_u32 v13, 4096, v13
    v_add_u32 v14, 128, v14
    s_sub_u32 s45, s45, 1
    s_cmp_lg_u32 s45, 0
    s_cbranch_scc1 L_f1_loop1
    s_branch L_f1_done
L_f1_v2:
    ds_read_b128 v[72:75], v10 offset:0
    ds_read_b128 v[76:79], v10 offset:20480
    ds_read_b128 v[84:87], v11 offset:0
    ds_read_b128 v[88:91], v11 offset:20480
L_f1_loop2:
    s_waitcnt lgkmcnt(2)
    s_nop 0
    v_mfma_f32_32x32x16_bf16 v[224:239], v[72:75], v[208:211], v[224:239]
    ds_read_b128 v[96:99], v12 offset:0
    v_fma_f32 v184, v19, v176, -v184
    v_fma_f32 v185, v19, v177, -v185
    v_fma_f32 v186, v19, v178, -v186
    v_fma_f32 v187, v19, v179, -v187
    v_fma_f32 v188, v19, v180, -v188
    v_fma_f32 v189, v19, v181, -v189
    v_fma_f32 v190, v19, v182, -v190
    v_fma_f32 v191, v19, v183, -v191
    v_fma_f32 v200, v19, v192, -v200
    v_fma_f32 v201, v19, v193, -v201
    v_fma_f32 v202, v19, v194, -v202
    v_fma_f32 v203, v19, v195, -v203
    v_mfma_f32_32x32x16_bf16 v[240:255], v[76:79], v[216:219], v[240:255]
    ds_read_b128 v[100:103], v12 offset:20480
    v_fma_f32 v204, v19, v196, -v204
    v_fma_f32 v205, v19, v197, -v205
    v_fma_f32 v206, v19, v198, -v206
    v_fma_f32 v207, v19, v199, -v207
    v_cvt_pk_bf16_f32 v212, v184, v185
    v_cvt_pk_bf16_f32 v213, v186, v187
    v_cvt_pk_bf16_f32 v214, v188, v189
    v_cvt_pk_bf16_f32 v215, v190, v191
    v_cvt_pk_bf16_f32 v220, v200, v201
    v_cvt_pk_bf16_f32 v221, v202, v203
    v_cvt_pk_bf16_f32 v222, v204, v205
    v_cvt_pk_bf16_f32 v223, v206, v207
    s_waitcnt lgkmcnt(2)
    s_nop 0
    v_mfma_f32_32x32x16_bf16 v[224:239], v[84:87], v[212:215], v[224:239]
    ds_read_b128 v[108:111], v13 offset:0
    v_fma_f32 v176, v19, v184, -v176
    v_fma_f32 v177, v19, v185, -v177
    v_fma_f32 v178, v19, v186, -v178
    v_fma_f32 v179, v19, v187, -v179
    v_fma_f32 v180, v19, v188, -v180
    v_fma_f32 v181, v19, v189, -v181
    v_fma_f32 v182, v19, v190, -v182
    v_fma_f32 v183, v19, v191, -v183
    v_fma_f32 v192, v19, v200, -v192
    v_fma_f32 v193, v19, v201, -v193
    v_fma_f32 v194, v19, v202, -v194
    v_fma_f32 v195, v19, v203, -v195
    v_mfma_f32_32x32x16_bf16 v[240:255], v[88:91], v[220:223], v[240:255]
    ds_read_b128 v[112:115], v13 offset:20480
    v_fma_f32 v196, v19, v204, -v196
    v_fma_f32 v197, v19, v205, -v197
    v_fma_f32 v198, v19, v206, -v198
    v_fma_f32 v199, v19, v207, -v199
    v_cvt_pk_bf16_f32 v208, v176, v177
    v_cvt_pk_bf16_f32 v209, v178, v179
    v_cvt_pk_bf16_f32 v210, v180, v181
    v_cvt_pk_bf16_f32 v211, v182, v183
    v_cvt_pk_bf16_f32 v216, v192, v193
    v_cvt_pk_bf16_f32 v217, v194, v195
    v_cvt_pk_bf16_f32 v218, v196, v197
    v_cvt_pk_bf16_f32 v219, v198, v199
    s_waitcnt lgkmcnt(2)
    s_nop 0
    v_mfma_f32_32x32x16_bf16 v[224:239], v[96:99], v[208:211], v[224:239]
    ds_read_b128 v[72:75], v10 offset:4096
    v_fma_f32 v184, v19, v176, -v184
    v_fma_f32 v185, v19, v177, -v185
    v_fma_f32 v186, v19, v178, -v186
    v_fma_f32 v187, v19, v179, -v187
    v_fma_f32 v188, v19, v180, -v188
    v_fma_f32 v189, v19, v181, -v189
    v_fma_f32 v190, v19, v182, -v190
    v_fma_f32 v191, v19, v183, -v191
    v_fma_f32 v200, v19, v192, -v200
    v_fma_f32 v201, v19, v193, -v201
    v_fma_f32 v202, v19, v194, -v202
    v_fma_f32 v203, v19, v195, -v203
    v_mfma_f32_32x32x16_bf16 v[240:255], v[100:103], v[216:219], v[240:255]
    ds_read_b128 v[76:79], v10 offset:24576
    v_fma_f32 v204, v19, v196, -v204
    v_fma_f32 v205, v19, v197, -v205
    v_fma_f32 v206, v19, v198, -v206
    v_fma_f32 v207, v19, v199, -v207
    v_cvt_pk_bf16_f32 v212, v184, v185
    v_cvt_pk_bf16_f32 v213, v186, v187
    v_cvt_pk_bf16_f32 v214, v188, v189
    v_cvt_pk_bf16_f32 v215, v190, v191
    v_cvt_pk_bf16_f32 v220, v200, v201
    v_cvt_pk_bf16_f32 v221, v202, v203
    v_cvt_pk_bf16_f32 v222, v204, v205
    v_cvt_pk_bf16_f32 v223, v206, v207
    s_waitcnt lgkmcnt(2)
    s_nop 0
    v_mfma_f32_32x32x16_bf16 v[224:239], v[108:111], v[212:215], v[224:239]
    ds_read_b128 v[84:87], v11 offset:4096
    v_fma_f32 v176, v19, v184, -v176
    v_fma_f32 v177, v19, v185, -v177
    v_fma_f32 v178, v19, v186, -v178
    v_fma_f32 v179, v19, v187, -v179
    v_fma_f32 v180, v19, v188, -v180
    v_fma_f32 v181, v19, v189, -v181
    v_fma_f32 v182, v19, v190, -v182
    v_fma_f32 v183, v19, v191, -v183
    v_fma_f32 v192, v19, v200, -v192
    v_fma_f32 v193, v19, v201, -v193
    v_fma_f32 v194, v19, v202, -v194
    v_fma_f32 v195, v19, v203, -v195
    v_mfma_f32_32x32x16_bf16 v[240:255], v[112:115], v[220:223], v[240:255]
    ds_read_b128 v[88:91], v11 offset:24576
    v_fma_f32 v196, v19, v204, -v196
    v_fma_f32 v197, v19, v205, -v197
    v_fma_f32 v198, v19, v206, -v198
    v_fma_f32 v199, v19, v207, -v199
    v_cvt_pk_bf16_f32 v208, v176, v177
    v_cvt_pk_bf16_f32 v209, v178, v179
    v_cvt_pk_bf16_f32 v210, v180, v181
    v_cvt_pk_bf16_f32 v211, v182, v183
    v_cvt_pk_bf16_f32 v216, v192, v193
    v_cvt_pk_bf16_f32 v217, v194, v195
    v_cvt_pk_bf16_f32 v218, v196, v197
    v_cvt_pk_bf16_f32 v219, v198, v199
    v_add_u32 v10, 4096, v10
    v_add_u32 v11, 4096, v11
    v_add_u32 v12, 4096, v12
    v_add_u32 v13, 4096, v13
    s_sub_u32 s45, s45, 1
    s_cmp_lg_u32 s45, 0
    s_cbranch_scc1 L_f1_loop2
    s_branch L_f1_done
L_f1_v3:
    ds_read_b128 v[72:75], v10 offset:0
    ds_read_b128 v[76:79], v10 offset:20480
    ds_read_b128 v[80:83], v14 offset:0
    ds_read_b128 v[84:87], v11 offset:0
    ds_read_b128 v[88:91], v11 offset:20480
    ds_read_b128 v[92:95], v14 offset:32
L_f1_loop3:
    s_waitcnt lgkmcnt(3)
    s_nop 0
    v_mfma_f32_32x32x16_bf16 v[224:239], v[72:75], v[208:211], v[224:239]
    ds_read_b128 v[96:99], v12 offset:0
    v_fma_f32 v184, v19, v176, -v184
    v_fma_f32 v185, v19, v177, -v185
    v_fma_f32 v186, v19, v178, -v186
    v_fma_f32 v187, v19, v179, -v187
    v_fma_f32 v188, v19, v180, -v188
    v_fma_f32 v189, v19, v181, -v189
    v_fma_f32 v190, v19, v182, -v190
    v_fma_f32 v191, v19, v183, -v191
    v_mfma_f32_32x32x16_bf16 v[240:255], v[76:79], v[216:219], v[240:255]
    ds_read_b128 v[100:103], v12 offset:20480
    v_fma_f32 v200, v19, v192, -v200
    v_fma_f32 v201, v19, v193, -v201
    v_fma_f32 v202, v19, v194, -v202
    v_fma_f32 v203, v19, v195, -v203
    v_fma_f32 v204, v19, v196, -v204
    v_fma_f32 v205, v19, v197, -v205
    v_fma_f32 v206, v19, v198, -v206
    v_fma_f32 v207, v19, v199, -v207
    v_mfma_f32_32x32x16_bf16 v[32:47], v[80:83], v[208:211], v[32:47]
    ds_read_b128 v[104:107], v14 offset:64
    v_cvt_pk_bf16_f32 v212, v184, v185
    v_cvt_pk_bf16_f32 v213, v186, v187
    v_cvt_pk_bf16_f32 v214, v188, v189
    v_cvt_pk_bf16_f32 v215, v190, v191
    v_cvt_pk_bf16_f32 v220, v200, v201
    v_cvt_pk_bf16_f32 v221, v202, v203
    v_cvt_pk_bf16_f32 v222, v204, v205
    v_cvt_pk_bf16_f32 v223, v206, v207
    s_waitcnt lgkmcnt(3)
    s_nop 0
    v_mfma_f32_32x32x16_bf16 v[224:239], v[84:87], v[212:215], v[224:239]
    ds_read_b128 v[108:111], v13 offset:0
    v_fma_f32 v176, v19, v184, -v176
    v_fma_f32 v177, v19, v185, -v177
    v_fma_f32 v178, v19, v186, -v178
    v_fma_f32 v179, v19, v187, -v179
    v_fma_f32 v180, v19, v188, -v180
    v_fma_f32 v181, v19, v189, -v181
    v_fma_f32 v182, v19, v190, -v182
    v_fma_f32 v183, v19, v191, -v183
    v_mfma_f32_32x32x16_bf16 v[240:255], v[88:91], v[220:223], v[240:255]
    ds_read_b128 v[112:115], v13 offset:20480
    v_fma_f32 v192, v19, v200, -v192
    v_fma_f32 v193, v19, v201, -v193
    v_fma_f32 v194, v19, v202, -v194
    v_fma_f32 v195, v19, v203, -v195
    v_fma_f32 v196, v19, v204, -v196
    v_fma_f32 v197, v19, v205, -v197
    v_fma_f32 v198, v19, v206, -v198
    v_fma_f32 v199, v19, v207, -v199
    v_mfma_f32_32x32x16_bf16 v[32:47], v[92:95], v[212:215], v[32:47]
    ds_read_b128 v[116:119], v14 offset:96
    v_cvt_pk_bf16_f32 v208, v176, v177
    v_cvt_pk_bf16_f32 v209, v178, v179
    v_cvt_pk_bf16_f32 v210, v180, v181
    v_cvt_pk_bf16_f32 v211, v182, v183
    v_cvt_pk_bf16_f32 v216, v192, v193
    v_cvt_pk_bf16_f32 v217, v194, v195
    v_cvt_pk_bf16_f32 v218, v196, v197
    v_cvt_pk_bf16_f32 v219, v198, v199
    s_waitcnt lgkmcnt(3)
    s_nop 0
    v_mfma_f32_32x32x16_bf16 v[224:239], v[96:99], v[208:211], v[224:239]
    ds_read_b128 v[72:75], v10 offset:4096
    v_fma_f32 v184, v19, v176, -v184
    v_fma_f32 v185, v19, v177, -v185
    v_fma_f32 v186, v19, v178, -v186
    v_fma_f32 v187, v19, v179, -v187
    v_fma_f32 v188, v19, v180, -v188
    v_fma_f32 v189, v19, v181, -v189
    v_fma_f32 v190, v19, v182, -v190
    v_fma_f32 v191, v19, v183, -v191
    v_mfma_f32_32x32x16_bf16 v[240:255], v[100:103], v[216:219], v[240:255]
    ds_read_b128 v[76:79], v10 offset:24576
    v_fma_f32 v200, v19, v192, -v200
    v_fma_f32 v201, v19, v193, -v201
    v_fma_f32 v202, v19, v194, -v202
    v_fma_f32 v203, v19, v195, -v203
    v_fma_f32 v204, v19, v196, -v204
    v_fma_f32 v205, v19, v197, -v205
    v_fma_f32 v206, v19, v198, -v206
    v_fma_f32 v207, v19, v199, -v207
    v_mfma_f32_32x32x16_bf16 v[32:47], v[104:107], v[208:211], v[32:47]
    ds_read_b128 v[80:83], v14 offset:128
    v_cvt_pk_bf16_f32 v212, v184, v185
    v_cvt_pk_bf16_f32 v213, v186, v187
    v_cvt_pk_bf16_f32 v214, v188, v189
    v_cvt_pk_bf16_f32 v215, v190, v191
    v_cvt_pk_bf16_f32 v220, v200, v201
    v_cvt_pk_bf16_f32 v221, v202, v203
    v_cvt_pk_bf16_f32 v222, v204, v205
    v_cvt_pk_bf16_f32 v223, v206, v207
    s_waitcnt lgkmcnt(3)
    s_nop 0
    v_mfma_f32_32x32x16_bf16 v[224:239], v[108:111], v[212:215], v[224:239]
    ds_read_b128 v[84:87], v11 offset:4096
    v_fma_f32 v176, v19, v184, -v176
    v_fma_f32 v177, v19, v185, -v177
    v_fma_f32 v178, v19, v186, -v178
    v_fma_f32 v179, v19, v187, -v179
    v_fma_f32 v180, v19, v188, -v180
    v_fma_f32 v181, v19, v189, -v181
    v_fma_f32 v182, v19, v190, -v182
    v_fma_f32 v183, v19, v191, -v183
    v_mfma_f32_32x32x16_bf16 v[240:255], v[112:115], v[220:223], v[240:255]
    ds_read_b128 v[88:91], v11 offset:24576
    v_fma_f32 v192, v19, v200, -v192
    v_fma_f32 v193, v19, v201, -v193
    v_fma_f32 v194, v19, v202, -v194
    v_fma_f32 v195, v19, v203, -v195
    v_fma_f32 v196, v19, v204, -v196
    v_fma_f32 v197, v19, v205, -v197
    v_fma_f32 v198, v19, v206, -v198
    v_fma_f32 v199, v19, v207, -v199
    v_mfma_f32_32x32x16_bf16 v[32:47], v[116:119], v[212:215], v[32:47]
    ds_read_b128 v[92:95], v14 offset:160
    v_cvt_pk_bf16_f32 v208, v176, v177
    v_cvt_pk_bf16_f32 v209, v178, v179
    v_cvt_pk_bf16_f32 v210, v180, v181
    v_cvt_pk_bf16_f32 v211, v182, v183
    v_cvt_pk_bf16_f32 v216, v192, v193
    v_cvt_pk_bf16_f32 v217, v194, v195
    v_cvt_pk_bf16_f32 v218, v196, v197
    v_cvt_pk_bf16_f32 v219, v198, v199
    v_add_u32 v10, 4096, v10
    v_add_u32 v11, 4096, v11
    v_add_u32 v12, 4096, v12
    v_add_u32 v13, 4096, v13
    v_add_u32 v14, 128, v14
    s_sub_u32 s45, s45, 1
    s_cmp_lg_u32 s45, 0
    s_cbranch_scc1 L_f1_loop3
L_f1_done:
    s_mul_i32 s43, s42, 33
    s_and_b32 s44, s26, 1
    s_lshl_b32 s44, s44, 4
    s_lshr_b32 s45, s26, 1
    s_add_u32 s44, s44, s45
    s_add_u32 s44, s44, s43
    s_mul_i32 s45, s50, 726
    s_add_u32 s44, s44, s45
    s_lshl_b32 s44, s44, 10
    s_waitcnt vmcnt(0) lgkmcnt(0)
    s_nop 5
    v_cvt_pk_bf16_f32 v224, v224, v225
    v_cvt_pk_bf16_f32 v225, v226, v227
    v_cvt_pk_bf16_f32 v226, v228, v229
    v_cvt_pk_bf16_f32 v227, v230, v231
    v_cvt_pk_bf16_f32 v228, v232, v233
    v_cvt_pk_bf16_f32 v229, v234, v235
    v_cvt_pk_bf16_f32 v230, v236, v237
    v_cvt_pk_bf16_f32 v231, v238, v239
    buffer_store_dwordx4 v[224:227], v15, s[36:39], s44 offen sc1
    s_add_u32 s44, s44, 371712
    buffer_store_dwordx4 v[228:231], v15, s[36:39], s44 offen sc1
    s_add_u32 s44, s44, 371712
    s_cmp_ge_u32 s3, 4
    s_cbranch_scc1 L_f1_one
    v_cvt_pk_bf16_f32 v240, v240, v241
    v_cvt_pk_bf16_f32 v241, v242, v243
    v_cvt_pk_bf16_f32 v242, v244, v245
    v_cvt_pk_bf16_f32 v243, v246, v247
    v_cvt_pk_bf16_f32 v244, v248, v249
    v_cvt_pk_bf16_f32 v245, v250, v251
    v_cvt_pk_bf16_f32 v246, v252, v253
    v_cvt_pk_bf16_f32 v247, v254, v255
    buffer_store_dwordx4 v[240:243], v15, s[36:39], s44 offen sc1
    s_add_u32 s44, s44, 371712
    buffer_store_dwordx4 v[244:247], v15, s[36:39], s44 offen sc1
    s_add_u32 s44, s44, 371712
L_f1_one:
    s_cmp_lg_u32 s51, 0
    s_cbranch_scc1 L_prep_done
    v_cvt_pk_bf16_f32 v32, v32, v33
    v_cvt_pk_bf16_f32 v33, v34, v35
    v_cvt_pk_bf16_f32 v34, v36, v37
    v_cvt_pk_bf16_f32 v35, v38, v39
    s_add_u32 s43, s43, 32
    s_lshl_b32 s43, s43, 10
    buffer_store_dwordx4 v[32:35], v15, s[36:39], s43 offen sc1
L_prep_done:
    s_cmp_lt_u32 s3, 5
    s_cbranch_scc1 L_prep_fin
    s_add_u32 s28, s16, 10485760
    s_addc_u32 s29, s17, 0
    s_mov_b32 s30, 3437568
    s_mov_b32 s31, 0x00020000
    v_lshl_or_b32 v120, v121, 16, v120
    v_lshl_or_b32 v121, v123, 16, v122
    v_lshl_or_b32 v122, v125, 16, v124
    v_lshl_or_b32 v123, v127, 16, v126
    buffer_store_dwordx4 v[120:123], v15, s[28:31], s56 offen sc1
    v_lshl_or_b32 v128, v129, 16, v128
    v_lshl_or_b32 v129, v131, 16, v130
    v_lshl_or_b32 v130, v133, 16, v132
    v_lshl_or_b32 v131, v135, 16, v134
    buffer_store_dwordx4 v[128:131], v15, s[28:31], s57 offen sc1
    v_lshl_or_b32 v136, v137, 16, v136
    v_lshl_or_b32 v137, v139, 16, v138
    v_lshl_or_b32 v138, v141, 16, v140
    v_lshl_or_b32 v139, v143, 16, v142
    buffer_store_dwordx4 v[136:139], v15, s[28:31], s96 offen sc1
    v_lshl_or_b32 v144, v145, 16, v144
    v_lshl_or_b32 v145, v147, 16, v146
    v_lshl_or_b32 v146, v149, 16, v148
    v_lshl_or_b32 v147, v151, 16, v150
    buffer_store_dwordx4 v[144:147], v15, s[28:31], s97 offen sc1
    s_cmp_ge_u32 s53, 32
    s_cbranch_scc1 L_sw_fin_13
    v_lshl_or_b32 v152, v153, 16, v152
    v_lshl_or_b32 v153, v155, 16, v154
    v_lshl_or_b32 v154, v157, 16, v156
    v_lshl_or_b32 v155, v159, 16, v158
    buffer_store_dwordx4 v[152:155], v15, s[28:31], s100 offen sc1
L_sw_fin_13:
L_prep_fin:
    v_readfirstlane_b32 s18, v4
    v_readfirstlane_b32 s19, v5
    s_nop 0
    s_cmp_lg_u32 s18, 0
    s_cbranch_scc1 L_A_done
    s_mov_b32 s28, s14
    s_mov_b32 s29, s15
    s_mov_b32 s30, 256
    s_mov_b32 s31, 0x00020000
    v_mov_b32 v2, 0
    s_mov_b32 s40, 200000
L_non_14:
    buffer_load_dwordx2 v[4:5], v2, s[28:31], 0 offen sc1
    s_waitcnt vmcnt(0)
    v_readfirstlane_b32 s18, v4
    v_readfirstlane_b32 s19, v5
    s_sub_u32 s40, s40, 1
    s_cmp_lg_u32 s18, 0
    s_cbranch_scc1 L_nonok_15
    s_cmp_eq_u32 s40, 0
    s_cbranch_scc1 L_nonok_15
    s_sleep 2
    s_branch L_non_14
L_nonok_15:
L_A_done:
    v_mov_b32 v23, 160704
    s_cmp_lg_u32 s3, 4
    s_cbranch_scc1 L_A_bar
    v_mov_b32 v2, s18
    v_mov_b32 v3, s19
    ds_write_b64 v23, v[2:3] offset:48
L_A_bar:
    s_waitcnt lgkmcnt(0)
    s_barrier
    s_lshr_b32 s26, s24, 1
    s_lshl_b32 s26, s26, 3
    s_and_b32 s27, s25, 7
    s_add_u32 s26, s26, s27
    s_and_b32 s27, s24, 1
    s_lshl_b32 s27, s27, 2
    s_lshr_b32 s40, s25, 3
    s_add_u32 s27, s27, s40
    s_cmp_ge_u32 s3, 4
    s_cbranch_scc1 L_aux
L_attn:
    ds_read_b32 v24, v23 offset:4
    ds_read_b64 v[26:27], v23 offset:48
    s_setprio 2
    s_mul_i32 s40, s26, 81920
    s_add_u32 s40, s40, 5242880
    s_add_u32 s28, s16, s40
    s_addc_u32 s29, s17, 0
    s_mov_b32 s30, 81920
    s_mov_b32 s31, 0x00020000
    s_mul_i32 s40, s26, 163840
    s_add_u32 s32, s16, s40
    s_addc_u32 s33, s17, 0
    s_mov_b32 s34, 163840
    s_mov_b32 s35, 0x00020000
    v_and_b32 v2, 31, v1
    v_lshrrev_b32 v3, 5, v1
    v_lshlrev_b32 v4, 4, v1
    v_lshlrev_b32 v5, 3, v2
    v_add_u32 v5, 1024, v5
    v_mov_b32 v20, 1073741824
    v_cmp_gt_u32 vcc, 32, v1
    s_lshl_b32 s41, s27, 3
    s_lshl_b32 s42, s3, 1
    s_add_u32 s41, s41, s42
    v_cndmask_b32 v20, v20, v5, vcc
    s_mul_i32 s42, s41, 1280
    v_and_b32 v21, 28, v2
    v_add_u32 v21, v21, v2
    v_lshl_add_u32 v21, v3, 2, v21
    v_lshlrev_b32 v21, 4, v21
    v_add_u32 v29, 1280, v21
    s_mov_b32 s48, 0x000fffff
    s_mov_b32 s49, 0x000fffff
    s_mov_b32 s52, 0x07060302
    s_waitcnt lgkmcnt(0)
    v_readfirstlane_b32 s47, v24
    v_readfirstlane_b32 s18, v26
    v_readfirstlane_b32 s19, v27
    s_mov_b32 s50, s47
    s_cmp_lg_u32 s47, 0
    s_cbranch_scc1 L_attn_go
    s_waitcnt vmcnt(0)
    v_mov_b32 v24, 1
    s_mov_b64 exec, 1
    ds_add_u32 v23, v24 offset:8
    s_mov_b64 exec, -1
L_attn_spin:
    s_sleep 1
    ds_read_b32 v24, v23 offset:4
    s_waitcnt lgkmcnt(0)
    v_readfirstlane_b32 s47, v24
    s_nop 0
    s_cmp_eq_u32 s47, 0
    s_cbranch_scc1 L_attn_spin
L_attn_go:
    s_sub_u32 s47, s47, 1
    s_mul_i32 s47, s47, 10240
    buffer_load_dwordx4 v[8:11], v4, s[28:31], s42 offen offset:0 sc1
    buffer_load_dwordx2 v[12:13], v20, s[28:31], s42 offen offset:0 sc1
    buffer_load_dwordx4 v[14:17], v4, s[28:31], s42 offen offset:1280 sc1
    buffer_load_dwordx2 v[18:19], v20, s[28:31], s42 offen offset:1280 sc1
    buffer_load_dwordx4 v[136:139], v4, s[32:35], s47 offen sc1
    v_mov_b32 v140, 0x3f803f80
    v_mov_b32 v141, 0x3f80
    v_mov_b32 v146, 0x3f803f80
    v_mov_b32 v147, 0x3f80
    s_mov_b32 exec_hi, 0
    buffer_load_dwordx2 v[140:141], v5, s[32:35], s47 offen sc1
    s_mov_b64 exec, -1
    v_mov_b32 v24, 0x3f803f80
    v_cmp_eq_u32 vcc, 20, v2
    s_add_u32 s43, s47, 2560
    s_nop 0
    v_cndmask_b32 v24, 0, v24, vcc
    v_mov_b32 v148, v24
    v_mov_b32 v149, v24
    v_mov_b32 v150, v24
    v_mov_b32 v151, v24
    v_mov_b32 v152, v24
    v_mov_b32 v153, v24
    v_mov_b32 v154, v24
    v_mov_b32 v155, v24
    v_mov_b32 v156, v24
    v_mov_b32 v157, v24
    v_mov_b32 v158, v24
    v_mov_b32 v159, v24
    v_mov_b32 v160, v24
    v_mov_b32 v161, v24
    v_mov_b32 v162, v24
    v_mov_b32 v163, v24
    buffer_load_dwordx4 v[142:145], v4, s[32:35], s43 offen sc1
    s_mov_b32 exec_hi, 0
    buffer_load_dwordx2 v[146:147], v5, s[32:35], s43 offen sc1
    s_mov_b64 exec, s[48:49]
    buffer_load_dwordx4 v[148:151], v29, s[32:35], s47 offen sc1
    buffer_load_dwordx4 v[152:155], v29, s[32:35], s47 offen offset:640 sc1
    buffer_load_dwordx4 v[156:159], v29, s[32:35], s43 offen sc1
    buffer_load_dwordx4 v[160:163], v29, s[32:35], s43 offen offset:640 sc1
    s_mov_b64 exec, -1
    s_cmp_eq_u32 s50, 0
    s_cbranch_scc1 L_attn_cnt
    s_waitcnt vmcnt(12)
    v_mov_b32 v24, 1
    s_mov_b64 exec, 1
    ds_add_u32 v23, v24 offset:8
    s_mov_b64 exec, -1
L_attn_cnt:
    v_mov_b32 v22, 5120
    v_cmp_lt_u32 vcc, 20, v2
    v_mov_b32 v21, 5136
    s_nop 0
    v_cndmask_b32 v22, v22, v21, vcc
    v_cmp_gt_u32 vcc, 20, v2
    v_add_u32 v168, 0, v29
    v_add_u32 v169, 640, v29
    v_add_u32 v170, 2560, v29
    v_add_u32 v171, 3200, v29
    v_cndmask_b32 v168, v22, v168, vcc
    v_cndmask_b32 v169, v22, v169, vcc
    v_cndmask_b32 v170, v22, v170, vcc
    v_cndmask_b32 v171, v22, v171, vcc
    v_cmp_gt_u32 vcc, 32, v1
    v_mov_b32 v22, 5152
    v_add_u32 v21, 2560, v5
    v_cndmask_b32 v172, v22, v5, vcc
    v_cndmask_b32 v173, v22, v21, vcc
    s_add_u32 s36, s16, 7864320
    s_addc_u32 s37, s17, 0
    s_mov_b32 s38, 2621440
    s_mov_b32 s39, 0x00020000
    v_mov_b32 v96, 0
    v_mov_b32 v97, 0
    v_mov_b32 v98, 0
    v_mov_b32 v99, 0
    v_mov_b32 v100, 0
    v_mov_b32 v101, 0
    v_mov_b32 v102, 0
    v_mov_b32 v103, 0
    v_mov_b32 v104, 0
    v_mov_b32 v105, 0
    v_mov_b32 v106, 0
    v_mov_b32 v107, 0
    v_mov_b32 v108, 0
    v_mov_b32 v109, 0
    v_mov_b32 v110, 0
    v_mov_b32 v111, 0
    v_mov_b32 v112, 0
    v_mov_b32 v113, 0
    v_mov_b32 v114, 0
    v_mov_b32 v115, 0
    v_mov_b32 v116, 0
    v_mov_b32 v117, 0
    v_mov_b32 v118, 0
    v_mov_b32 v119, 0
    v_mov_b32 v120, 0
    v_mov_b32 v121, 0
    v_mov_b32 v122, 0
    v_mov_b32 v123, 0
    v_mov_b32 v124, 0
    v_mov_b32 v125, 0
    v_mov_b32 v126, 0
    v_mov_b32 v127, 0
    s_waitcnt vmcnt(6)
    v_mfma_f32_32x32x16_bf16 v[64:79], v[136:139], v[8:11], 0
    v_mfma_f32_32x32x8_bf16 v[64:79], v[140:141], v[12:13], v[64:79]
    v_mfma_f32_32x32x16_bf16 v[80:95], v[136:139], v[14:17], 0
    v_mfma_f32_32x32x8_bf16 v[80:95], v[140:141], v[18:19], v[80:95]
    s_mov_b32 s45, 0xffff0000
    s_mov_b32 s46, 0x07060302
    ds_read_b32 v164, v23
    s_nop 6
    v_max3_f32 v24, v64, v65, v66
    v_max_f32 v24, v24, v79
    v_max3_f32 v24, v24, v67, v68
    v_max3_f32 v24, v24, v69, v70
    v_max3_f32 v24, v24, v71, v72
    v_max3_f32 v24, v24, v73, v74
    v_max3_f32 v24, v24, v75, v76
    v_max3_f32 v24, v24, v77, v78
    v_mov_b32 v26, v24
    s_nop 1
    v_permlane32_swap_b32 v24, v26
    s_nop 0
    v_max_f32 v24, v24, v26
    v_sub_f32 v24, 0xc2c80000, v24
    v_and_b32 v26, s45, v24
    v_sub_f32 v27, v24, v26
    v_and_b32 v28, s45, v27
    v_sub_f32 v27, v27, v28
    s_mov_b32 exec_lo, 0
    v_perm_b32 v12, v28, v26, s46
    v_lshrrev_b32 v13, 16, v27
    s_mov_b64 exec, -1
    s_nop 0
    v_mfma_f32_32x32x16_bf16 v[64:79], v[136:139], v[8:11], 0
    v_mfma_f32_32x32x8_bf16 v[64:79], v[140:141], v[12:13], v[64:79]
    v_max3_f32 v25, v80, v81, v82
    v_max_f32 v25, v25, v95
    v_max3_f32 v25, v25, v83, v84
    v_max3_f32 v25, v25, v85, v86
    v_max3_f32 v25, v25, v87, v88
    v_max3_f32 v25, v25, v89, v90
    v_max3_f32 v25, v25, v91, v92
    v_max3_f32 v25, v25, v93, v94
    v_mov_b32 v26, v25
    s_nop 1
    v_permlane32_swap_b32 v25, v26
    s_nop 0
    v_max_f32 v25, v25, v26
    v_sub_f32 v25, 0xc2c80000, v25
    v_and_b32 v26, s45, v25
    v_sub_f32 v27, v25, v26
    v_and_b32 v28, s45, v27
    v_sub_f32 v27, v27, v28
    s_mov_b32 exec_lo, 0
    v_perm_b32 v18, v28, v26, s46
    v_lshrrev_b32 v19, 16, v27
    s_mov_b64 exec, -1
    s_waitcnt vmcnt(0)
.p2align 3
    v_exp_f32 v64, v64
    v_exp_f32 v65, v65
    v_exp_f32 v66, v66
    v_exp_f32 v67, v67
    v_exp_f32 v68, v68
    v_mfma_f32_32x32x16_bf16 v[80:95], v[136:139], v[14:17], 0
    v_exp_f32 v69, v69
    v_exp_f32 v70, v70
    v_exp_f32 v71, v71
    v_cvt_pk_bf16_f32 v128, v64, v65
    v_cvt_pk_bf16_f32 v129, v66, v67
    v_cvt_pk_bf16_f32 v130, v68, v69
    v_cvt_pk_bf16_f32 v131, v70, v71
    v_mfma_f32_32x32x8_bf16 v[80:95], v[140:141], v[18:19], v[80:95]
    v_exp_f32 v72, v72
    v_exp_f32 v73, v73
    v_exp_f32 v74, v74
    v_exp_f32 v75, v75
    v_exp_f32 v76, v76
    v_mfma_f32_32x32x16_bf16 v[96:111], v[148:151], v[128:131], v[96:111]
    v_exp_f32 v77, v77
    v_exp_f32 v78, v78
    v_exp_f32 v79, v79
    v_cvt_pk_bf16_f32 v132, v72, v73
    v_cvt_pk_bf16_f32 v133, v74, v75
    v_cvt_pk_bf16_f32 v134, v76, v77
    v_cvt_pk_bf16_f32 v135, v78, v79
L_chk_16:
    s_waitcnt lgkmcnt(0)
    v_readfirstlane_b32 s44, v164
    s_nop 0
    s_cmp_ge_u32 s44, 1
    s_cbranch_scc1 L_chkok_17
    ds_read_b32 v164, v23
    s_branch L_chk_16
.p2align 3
L_chkok_17:
    v_exp_f32 v80, v80
    v_exp_f32 v81, v81
    v_mfma_f32_32x32x16_bf16 v[96:111], v[152:155], v[132:135], v[96:111]
    s_waitcnt lgkmcnt(0)
    v_exp_f32 v82, v82
    v_exp_f32 v83, v83
    v_exp_f32 v84, v84
    v_mfma_f32_32x32x16_bf16 v[64:79], v[142:145], v[8:11], 0
    ds_read_b128 v[136:139], v4 offset:0
    v_exp_f32 v85, v85
    v_exp_f32 v86, v86
    v_exp_f32 v87, v87
    v_cvt_pk_bf16_f32 v128, v80, v81
    v_cvt_pk_bf16_f32 v129, v82, v83
    v_cvt_pk_bf16_f32 v130, v84, v85
    v_cvt_pk_bf16_f32 v131, v86, v87
    v_mfma_f32_32x32x8_bf16 v[64:79], v[146:147], v[12:13], v[64:79]
    v_exp_f32 v88, v88
    v_exp_f32 v89, v89
    v_exp_f32 v90, v90
    v_exp_f32 v91, v91
    v_exp_f32 v92, v92
    v_mfma_f32_32x32x16_bf16 v[112:127], v[148:151], v[128:131], v[112:127]
    ds_read_b64 v[140:141], v172 offset:0
    v_exp_f32 v93, v93
    v_exp_f32 v94, v94
    v_exp_f32 v95, v95
    v_cvt_pk_bf16_f32 v132, v88, v89
    v_cvt_pk_bf16_f32 v133, v90, v91
    v_cvt_pk_bf16_f32 v134, v92, v93
    v_cvt_pk_bf16_f32 v135, v94, v95
    v_exp_f32 v64, v64
    v_exp_f32 v65, v65
    v_mfma_f32_32x32x16_bf16 v[112:127], v[152:155], v[132:135], v[112:127]
    ds_read_b128 v[148:151], v168 offset:0
    v_exp_f32 v66, v66
    v_exp_f32 v67, v67
    v_exp_f32 v68, v68
    v_mfma_f32_32x32x16_bf16 v[80:95], v[142:145], v[14:17], 0
    ds_read_b128 v[152:155], v169 offset:0
    v_exp_f32 v69, v69
    v_exp_f32 v70, v70
    v_exp_f32 v71, v71
    v_cvt_pk_bf16_f32 v128, v64, v65
    v_cvt_pk_bf16_f32 v129, v66, v67
    v_cvt_pk_bf16_f32 v130, v68, v69
    v_cvt_pk_bf16_f32 v131, v70, v71
    v_mfma_f32_32x32x8_bf16 v[80:95], v[146:147], v[18:19], v[80:95]
    v_exp_f32 v72, v72
    v_exp_f32 v73, v73
    v_exp_f32 v74, v74
    v_exp_f32 v75, v75
    v_exp_f32 v76, v76
    v_mfma_f32_32x32x16_bf16 v[96:111], v[156:159], v[128:131], v[96:111]
    v_exp_f32 v77, v77
    v_exp_f32 v78, v78
    v_exp_f32 v79, v79
    v_cvt_pk_bf16_f32 v132, v72, v73
    v_cvt_pk_bf16_f32 v133, v74, v75
    v_cvt_pk_bf16_f32 v134, v76, v77
    v_cvt_pk_bf16_f32 v135, v78, v79
    v_exp_f32 v80, v80
    v_exp_f32 v81, v81
    v_mfma_f32_32x32x16_bf16 v[96:111], v[160:163], v[132:135], v[96:111]
    s_waitcnt lgkmcnt(0)
    v_exp_f32 v82, v82
    v_exp_f32 v83, v83
    v_exp_f32 v84, v84
    v_mfma_f32_32x32x16_bf16 v[64:79], v[136:139], v[8:11], 0
    ds_read_b128 v[142:145], v4 offset:2560
    v_exp_f32 v85, v85
    v_exp_f32 v86, v86
    v_exp_f32 v87, v87
    v_cvt_pk_bf16_f32 v128, v80, v81
    v_cvt_pk_bf16_f32 v129, v82, v83
    v_cvt_pk_bf16_f32 v130, v84, v85
    v_cvt_pk_bf16_f32 v131, v86, v87
    v_mfma_f32_32x32x8_bf16 v[64:79], v[140:141], v[12:13], v[64:79]
    v_exp_f32 v88, v88
    v_exp_f32 v89, v89
    v_exp_f32 v90, v90
    v_exp_f32 v91, v91
    v_exp_f32 v92, v92
    v_mfma_f32_32x32x16_bf16 v[112:127], v[156:159], v[128:131], v[112:127]
    ds_read_b64 v[146:147], v173 offset:0
    v_exp_f32 v93, v93
    v_exp_f32 v94, v94
    v_exp_f32 v95, v95
    v_cvt_pk_bf16_f32 v132, v88, v89
    v_cvt_pk_bf16_f32 v133, v90, v91
    v_cvt_pk_bf16_f32 v134, v92, v93
    v_cvt_pk_bf16_f32 v135, v94, v95
    v_exp_f32 v64, v64
    v_exp_f32 v65, v65
    v_mfma_f32_32x32x16_bf16 v[112:127], v[160:163], v[132:135], v[112:127]
    ds_read_b128 v[156:159], v170 offset:0
    v_exp_f32 v66, v66
    v_exp_f32 v67, v67
    v_exp_f32 v68, v68
    v_mfma_f32_32x32x16_bf16 v[80:95], v[136:139], v[14:17], 0
    ds_read_b128 v[160:163], v171 offset:0
    v_exp_f32 v69, v69
    v_exp_f32 v70, v70
    v_exp_f32 v71, v71
    v_cvt_pk_bf16_f32 v128, v64, v65
    v_cvt_pk_bf16_f32 v129, v66, v67
    v_cvt_pk_bf16_f32 v130, v68, v69
    v_cvt_pk_bf16_f32 v131, v70, v71
    v_mfma_f32_32x32x8_bf16 v[80:95], v[140:141], v[18:19], v[80:95]
    v_exp_f32 v72, v72
    v_exp_f32 v73, v73
    v_exp_f32 v74, v74
    v_exp_f32 v75, v75
    v_exp_f32 v76, v76
    v_mfma_f32_32x32x16_bf16 v[96:111], v[148:151], v[128:131], v[96:111]
    ds_read_b32 v164, v23
    v_exp_f32 v77, v77
    v_exp_f32 v78, v78
    v_exp_f32 v79, v79
    v_cvt_pk_bf16_f32 v132, v72, v73
    v_cvt_pk_bf16_f32 v133, v74, v75
    v_cvt_pk_bf16_f32 v134, v76, v77
    v_cvt_pk_bf16_f32 v135, v78, v79
L_chk_18:
    s_waitcnt lgkmcnt(0)
    v_readfirstlane_b32 s44, v164
    s_nop 0
    s_cmp_ge_u32 s44, 2
    s_cbranch_scc1 L_chkok_19
    ds_read_b32 v164, v23
    s_branch L_chk_18
.p2align 3
L_chkok_19:
    v_exp_f32 v80, v80
    v_exp_f32 v81, v81
    v_mfma_f32_32x32x16_bf16 v[96:111], v[152:155], v[132:135], v[96:111]
    s_waitcnt lgkmcnt(0)
    v_exp_f32 v82, v82
    v_exp_f32 v83, v83
    v_exp_f32 v84, v84
    v_mfma_f32_32x32x16_bf16 v[64:79], v[142:145], v[8:11], 0
    ds_read_b128 v[136:139], v4 offset:5184
    v_exp_f32 v85, v85
    v_exp_f32 v86, v86
    v_exp_f32 v87, v87
    v_cvt_pk_bf16_f32 v128, v80, v81
    v_cvt_pk_bf16_f32 v129, v82, v83
    v_cvt_pk_bf16_f32 v130, v84, v85
    v_cvt_pk_bf16_f32 v131, v86, v87
    v_mfma_f32_32x32x8_bf16 v[64:79], v[146:147], v[12:13], v[64:79]
    v_exp_f32 v88, v88
    v_exp_f32 v89, v89
    v_exp_f32 v90, v90
    v_exp_f32 v91, v91
    v_exp_f32 v92, v92
    v_mfma_f32_32x32x16_bf16 v[112:127], v[148:151], v[128:131], v[112:127]
    ds_read_b64 v[140:141], v172 offset:5184
    v_exp_f32 v93, v93
    v_exp_f32 v94, v94
    v_exp_f32 v95, v95
    v_cvt_pk_bf16_f32 v132, v88, v89
    v_cvt_pk_bf16_f32 v133, v90, v91
    v_cvt_pk_bf16_f32 v134, v92, v93
    v_cvt_pk_bf16_f32 v135, v94, v95
    v_exp_f32 v64, v64
    v_exp_f32 v65, v65
    v_mfma_f32_32x32x16_bf16 v[112:127], v[152:155], v[132:135], v[112:127]
    ds_read_b128 v[148:151], v168 offset:5184
    v_exp_f32 v66, v66
    v_exp_f32 v67, v67
    v_exp_f32 v68, v68
    v_mfma_f32_32x32x16_bf16 v[80:95], v[142:145], v[14:17], 0
    ds_read_b128 v[152:155], v169 offset:5184
    v_exp_f32 v69, v69
    v_exp_f32 v70, v70
    v_exp_f32 v71, v71
    v_cvt_pk_bf16_f32 v128, v64, v65
    v_cvt_pk_bf16_f32 v129, v66, v67
    v_cvt_pk_bf16_f32 v130, v68, v69
    v_cvt_pk_bf16_f32 v131, v70, v71
    v_mfma_f32_32x32x8_bf16 v[80:95], v[146:147], v[18:19], v[80:95]
    v_exp_f32 v72, v72
    v_exp_f32 v73, v73
    v_exp_f32 v74, v74
    v_exp_f32 v75, v75
    v_exp_f32 v76, v76
    v_mfma_f32_32x32x16_bf16 v[96:111], v[156:159], v[128:131], v[96:111]
    v_exp_f32 v77, v77
    v_exp_f32 v78, v78
    v_exp_f32 v79, v79
    v_cvt_pk_bf16_f32 v132, v72, v73
    v_cvt_pk_bf16_f32 v133, v74, v75
    v_cvt_pk_bf16_f32 v134, v76, v77
    v_cvt_pk_bf16_f32 v135, v78, v79
    v_exp_f32 v80, v80
    v_exp_f32 v81, v81
    v_mfma_f32_32x32x16_bf16 v[96:111], v[160:163], v[132:135], v[96:111]
    s_waitcnt lgkmcnt(0)
    v_exp_f32 v82, v82
    v_exp_f32 v83, v83
    v_exp_f32 v84, v84
    v_mfma_f32_32x32x16_bf16 v[64:79], v[136:139], v[8:11], 0
    ds_read_b128 v[142:145], v4 offset:7744
    v_exp_f32 v85, v85
    v_exp_f32 v86, v86
    v_exp_f32 v87, v87
    v_cvt_pk_bf16_f32 v128, v80, v81
    v_cvt_pk_bf16_f32 v129, v82, v83
    v_cvt_pk_bf16_f32 v130, v84, v85
    v_cvt_pk_bf16_f32 v131, v86, v87
    v_mfma_f32_32x32x8_bf16 v[64:79], v[140:141], v[12:13], v[64:79]
    v_exp_f32 v88, v88
    v_exp_f32 v89, v89
    v_exp_f32 v90, v90
    v_exp_f32 v91, v91
    v_exp_f32 v92, v92
    v_mfma_f32_32x32x16_bf16 v[112:127], v[156:159], v[128:131], v[112:127]
    ds_read_b64 v[146:147], v173 offset:5184
    v_exp_f32 v93, v93
    v_exp_f32 v94, v94
    v_exp_f32 v95, v95
    v_cvt_pk_bf16_f32 v132, v88, v89
    v_cvt_pk_bf16_f32 v133, v90, v91
    v_cvt_pk_bf16_f32 v134, v92, v93
    v_cvt_pk_bf16_f32 v135, v94, v95
    v_exp_f32 v64, v64
    v_exp_f32 v65, v65
    v_mfma_f32_32x32x16_bf16 v[112:127], v[160:163], v[132:135], v[112:127]
    ds_read_b128 v[156:159], v170 offset:5184
    v_exp_f32 v66, v66
    v_exp_f32 v67, v67
    v_exp_f32 v68, v68
    v_mfma_f32_32x32x16_bf16 v[80:95], v[136:139], v[14:17], 0
    ds_read_b128 v[160:163], v171 offset:5184
    v_exp_f32 v69, v69
    v_exp_f32 v70, v70
    v_exp_f32 v71, v71
    v_cvt_pk_bf16_f32 v128, v64, v65
    v_cvt_pk_bf16_f32 v129, v66, v67
    v_cvt_pk_bf16_f32 v130, v68, v69
    v_cvt_pk_bf16_f32 v131, v70, v71
    v_mfma_f32_32x32x8_bf16 v[80:95], v[140:141], v[18:19], v[80:95]
    v_exp_f32 v72, v72
    v_exp_f32 v73, v73
    v_exp_f32 v74, v74
    v_exp_f32 v75, v75
    v_exp_f32 v76, v76
    v_mfma_f32_32x32x16_bf16 v[96:111], v[148:151], v[128:131], v[96:111]
    v_exp_f32 v77, v77
    v_exp_f32 v78, v78
    v_exp_f32 v79, v79
    v_cvt_pk_bf16_f32 v132, v72, v73
    v_cvt_pk_bf16_f32 v133, v74, v75
    v_cvt_pk_bf16_f32 v134, v76, v77
    v_cvt_pk_bf16_f32 v135, v78, v79
    v_exp_f32 v80, v80
    v_exp_f32 v81, v81
    v_mfma_f32_32x32x16_bf16 v[96:111], v[152:155], v[132:135], v[96:111]
    s_waitcnt lgkmcnt(0)
    v_exp_f32 v82, v82
    v_exp_f32 v83, v83
    v_exp_f32 v84, v84
    v_mfma_f32_32x32x16_bf16 v[64:79], v[142:145], v[8:11], 0
    ds_read_b128 v[136:139], v4 offset:10368
    v_exp_f32 v85, v85
    v_exp_f32 v86, v86
    v_exp_f32 v87, v87
    v_cvt_pk_bf16_f32 v128, v80, v81
    v_cvt_pk_bf16_f32 v129, v82, v83
    v_cvt_pk_bf16_f32 v130, v84, v85
    v_cvt_pk_bf16_f32 v131, v86, v87
    v_mfma_f32_32x32x8_bf16 v[64:79], v[146:147], v[12:13], v[64:79]
    v_exp_f32 v88, v88
    v_exp_f32 v89, v89
    v_exp_f32 v90, v90
    v_exp_f32 v91, v91
    v_exp_f32 v92, v92
    v_mfma_f32_32x32x16_bf16 v[112:127], v[148:151], v[128:131], v[112:127]
    ds_read_b64 v[140:141], v172 offset:10368
    v_exp_f32 v93, v93
    v_exp_f32 v94, v94
    v_exp_f32 v95, v95
    v_cvt_pk_bf16_f32 v132, v88, v89
    v_cvt_pk_bf16_f32 v133, v90, v91
    v_cvt_pk_bf16_f32 v134, v92, v93
    v_cvt_pk_bf16_f32 v135, v94, v95
    v_exp_f32 v64, v64
    v_exp_f32 v65, v65
    v_mfma_f32_32x32x16_bf16 v[112:127], v[152:155], v[132:135], v[112:127]
    ds_read_b128 v[148:151], v168 offset:10368
    v_exp_f32 v66, v66
    v_exp_f32 v67, v67
    v_exp_f32 v68, v68
    v_mfma_f32_32x32x16_bf16 v[80:95], v[142:145], v[14:17], 0
    ds_read_b128 v[152:155], v169 offset:10368
    v_exp_f32 v69, v69
    v_exp_f32 v70, v70
    v_exp_f32 v71, v71
    v_cvt_pk_bf16_f32 v128, v64, v65
    v_cvt_pk_bf16_f32 v129, v66, v67
    v_cvt_pk_bf16_f32 v130, v68, v69
    v_cvt_pk_bf16_f32 v131, v70, v71
    v_mfma_f32_32x32x8_bf16 v[80:95], v[146:147], v[18:19], v[80:95]
    v_exp_f32 v72, v72
    v_exp_f32 v73, v73
    v_exp_f32 v74, v74
    v_exp_f32 v75, v75
    v_exp_f32 v76, v76
    v_mfma_f32_32x32x16_bf16 v[96:111], v[156:159], v[128:131], v[96:111]
    v_exp_f32 v77, v77
    v_exp_f32 v78, v78
    v_exp_f32 v79, v79
    v_cvt_pk_bf16_f32 v132, v72, v73
    v_cvt_pk_bf16_f32 v133, v74, v75
    v_cvt_pk_bf16_f32 v134, v76, v77
    v_cvt_pk_bf16_f32 v135, v78, v79
    v_exp_f32 v80, v80
    v_exp_f32 v81, v81
    v_mfma_f32_32x32x16_bf16 v[96:111], v[160:163], v[132:135], v[96:111]
    s_waitcnt lgkmcnt(0)
    v_exp_f32 v82, v82
    v_exp_f32 v83, v83
    v_exp_f32 v84, v84
    v_mfma_f32_32x32x16_bf16 v[64:79], v[136:139], v[8:11], 0
    ds_read_b128 v[142:145], v4 offset:12928
    v_exp_f32 v85, v85
    v_exp_f32 v86, v86
    v_exp_f32 v87, v87
    v_cvt_pk_bf16_f32 v128, v80, v81
    v_cvt_pk_bf16_f32 v129, v82, v83
    v_cvt_pk_bf16_f32 v130, v84, v85
    v_cvt_pk_bf16_f32 v131, v86, v87
    v_mfma_f32_32x32x8_bf16 v[64:79], v[140:141], v[12:13], v[64:79]
    v_exp_f32 v88, v88
    v_exp_f32 v89, v89
    v_exp_f32 v90, v90
    v_exp_f32 v91, v91
    v_exp_f32 v92, v92
    v_mfma_f32_32x32x16_bf16 v[112:127], v[156:159], v[128:131], v[112:127]
    ds_read_b64 v[146:147], v173 offset:10368
    v_exp_f32 v93, v93
    v_exp_f32 v94, v94
    v_exp_f32 v95, v95
    v_cvt_pk_bf16_f32 v132, v88, v89
    v_cvt_pk_bf16_f32 v133, v90, v91
    v_cvt_pk_bf16_f32 v134, v92, v93
    v_cvt_pk_bf16_f32 v135, v94, v95
    v_exp_f32 v64, v64
    v_exp_f32 v65, v65
    v_mfma_f32_32x32x16_bf16 v[112:127], v[160:163], v[132:135], v[112:127]
    ds_read_b128 v[156:159], v170 offset:10368
    v_exp_f32 v66, v66
    v_exp_f32 v67, v67
    v_exp_f32 v68, v68
    v_mfma_f32_32x32x16_bf16 v[80:95], v[136:139], v[14:17], 0
    ds_read_b128 v[160:163], v171 offset:10368
    v_exp_f32 v69, v69
    v_exp_f32 v70, v70
    v_exp_f32 v71, v71
    v_cvt_pk_bf16_f32 v128, v64, v65
    v_cvt_pk_bf16_f32 v129, v66, v67
    v_cvt_pk_bf16_f32 v130, v68, v69
    v_cvt_pk_bf16_f32 v131, v70, v71
    v_mfma_f32_32x32x8_bf16 v[80:95], v[140:141], v[18:19], v[80:95]
    v_exp_f32 v72, v72
    v_exp_f32 v73, v73
    v_exp_f32 v74, v74
    v_exp_f32 v75, v75
    v_exp_f32 v76, v76
    v_mfma_f32_32x32x16_bf16 v[96:111], v[148:151], v[128:131], v[96:111]
    ds_read_b32 v164, v23
    v_exp_f32 v77, v77
    v_exp_f32 v78, v78
    v_exp_f32 v79, v79
    v_cvt_pk_bf16_f32 v132, v72, v73
    v_cvt_pk_bf16_f32 v133, v74, v75
    v_cvt_pk_bf16_f32 v134, v76, v77
    v_cvt_pk_bf16_f32 v135, v78, v79
    v_add_u32 v4, 15552, v4
    v_add_u32 v168, 15552, v168
    v_add_u32 v169, 15552, v169
    v_add_u32 v170, 15552, v170
    v_add_u32 v171, 15552, v171
    v_add_u32 v172, 15552, v172
    v_add_u32 v173, 15552, v173
    s_lshl_b32 s45, s3, 2
    v_add_u32 v24, s45, v23
    ds_write_b32 v24, v23 offset:16
    s_mov_b32 s45, 2
    s_mov_b32 s46, 7
    s_cmp_eq_u32 s44, 16
    s_cbranch_scc1 L_attn_fast
.p2align 3
L_attn_loop:
    s_add_u32 s45, s45, 2
L_chk_20:
    s_waitcnt lgkmcnt(0)
    v_readfirstlane_b32 s44, v164
    s_nop 0
    s_cmp_ge_u32 s44, s45
    s_cbranch_scc1 L_chkok_21
    ds_read_b32 v164, v23
    s_branch L_chk_20
.p2align 3
L_chkok_21:
    v_exp_f32 v80, v80
    v_exp_f32 v81, v81
    v_mfma_f32_32x32x16_bf16 v[96:111], v[152:155], v[132:135], v[96:111]
    s_waitcnt lgkmcnt(0)
    v_exp_f32 v82, v82
    v_exp_f32 v83, v83
    v_exp_f32 v84, v84
    v_mfma_f32_32x32x16_bf16 v[64:79], v[142:145], v[8:11], 0
    ds_read_b128 v[136:139], v4 offset:0
    v_exp_f32 v85, v85
    v_exp_f32 v86, v86
    v_exp_f32 v87, v87
    v_cvt_pk_bf16_f32 v128, v80, v81
    v_cvt_pk_bf16_f32 v129, v82, v83
    v_cvt_pk_bf16_f32 v130, v84, v85
    v_cvt_pk_bf16_f32 v131, v86, v87
    v_mfma_f32_32x32x8_bf16 v[64:79], v[146:147], v[12:13], v[64:79]
    v_exp_f32 v88, v88
    v_exp_f32 v89, v89
    v_exp_f32 v90, v90
    v_exp_f32 v91, v91
    v_exp_f32 v92, v92
    v_mfma_f32_32x32x16_bf16 v[112:127], v[148:151], v[128:131], v[112:127]
    ds_read_b64 v[140:141], v172 offset:0
    v_exp_f32 v93, v93
    v_exp_f32 v94, v94
    v_exp_f32 v95, v95
    v_cvt_pk_bf16_f32 v132, v88, v89
    v_cvt_pk_bf16_f32 v133, v90, v91
    v_cvt_pk_bf16_f32 v134, v92, v93
    v_cvt_pk_bf16_f32 v135, v94, v95
    v_exp_f32 v64, v64
    v_exp_f32 v65, v65
    v_mfma_f32_32x32x16_bf16 v[112:127], v[152:155], v[132:135], v[112:127]
    ds_read_b128 v[148:151], v168 offset:0
    v_exp_f32 v66, v66
    v_exp_f32 v67, v67
    v_exp_f32 v68, v68
    v_mfma_f32_32x32x16_bf16 v[80:95], v[142:145], v[14:17], 0
    ds_read_b128 v[152:155], v169 offset:0
    v_exp_f32 v69, v69
    v_exp_f32 v70, v70
    v_exp_f32 v71, v71
    v_cvt_pk_bf16_f32 v128, v64, v65
    v_cvt_pk_bf16_f32 v129, v66, v67
    v_cvt_pk_bf16_f32 v130, v68, v69
    v_cvt_pk_bf16_f32 v131, v70, v71
    v_mfma_f32_32x32x8_bf16 v[80:95], v[146:147], v[18:19], v[80:95]
    v_exp_f32 v72, v72
    v_exp_f32 v73, v73
    v_exp_f32 v74, v74
    v_exp_f32 v75, v75
    v_exp_f32 v76, v76
    v_mfma_f32_32x32x16_bf16 v[96:111], v[156:159], v[128:131], v[96:111]
    v_exp_f32 v77, v77
    v_exp_f32 v78, v78
    v_exp_f32 v79, v79
    v_cvt_pk_bf16_f32 v132, v72, v73
    v_cvt_pk_bf16_f32 v133, v74, v75
    v_cvt_pk_bf16_f32 v134, v76, v77
    v_cvt_pk_bf16_f32 v135, v78, v79
    v_exp_f32 v80, v80
    v_exp_f32 v81, v81
    v_mfma_f32_32x32x16_bf16 v[96:111], v[160:163], v[132:135], v[96:111]
    s_waitcnt lgkmcnt(0)
    v_exp_f32 v82, v82
    v_exp_f32 v83, v83
    v_exp_f32 v84, v84
    v_mfma_f32_32x32x16_bf16 v[64:79], v[136:139], v[8:11], 0
    ds_read_b128 v[142:145], v4 offset:2560
    v_exp_f32 v85, v85
    v_exp_f32 v86, v86
    v_exp_f32 v87, v87
    v_cvt_pk_bf16_f32 v128, v80, v81
    v_cvt_pk_bf16_f32 v129, v82, v83
    v_cvt_pk_bf16_f32 v130, v84, v85
    v_cvt_pk_bf16_f32 v131, v86, v87
    v_mfma_f32_32x32x8_bf16 v[64:79], v[140:141], v[12:13], v[64:79]
    v_exp_f32 v88, v88
    v_exp_f32 v89, v89
    v_exp_f32 v90, v90
    v_exp_f32 v91, v91
    v_exp_f32 v92, v92
    v_mfma_f32_32x32x16_bf16 v[112:127], v[156:159], v[128:131], v[112:127]
    ds_read_b64 v[146:147], v173 offset:0
    v_exp_f32 v93, v93
    v_exp_f32 v94, v94
    v_exp_f32 v95, v95
    v_cvt_pk_bf16_f32 v132, v88, v89
    v_cvt_pk_bf16_f32 v133, v90, v91
    v_cvt_pk_bf16_f32 v134, v92, v93
    v_cvt_pk_bf16_f32 v135, v94, v95
    v_exp_f32 v64, v64
    v_exp_f32 v65, v65
    v_mfma_f32_32x32x16_bf16 v[112:127], v[160:163], v[132:135], v[112:127]
    ds_read_b128 v[156:159], v170 offset:0
    v_exp_f32 v66, v66
    v_exp_f32 v67, v67
    v_exp_f32 v68, v68
    v_mfma_f32_32x32x16_bf16 v[80:95], v[136:139], v[14:17], 0
    ds_read_b128 v[160:163], v171 offset:0
    v_exp_f32 v69, v69
    v_exp_f32 v70, v70
    v_exp_f32 v71, v71
    v_cvt_pk_bf16_f32 v128, v64, v65
    v_cvt_pk_bf16_f32 v129, v66, v67
    v_cvt_pk_bf16_f32 v130, v68, v69
    v_cvt_pk_bf16_f32 v131, v70, v71
    v_mfma_f32_32x32x8_bf16 v[80:95], v[140:141], v[18:19], v[80:95]
    v_exp_f32 v72, v72
    v_exp_f32 v73, v73
    v_exp_f32 v74, v74
    v_exp_f32 v75, v75
    v_exp_f32 v76, v76
    v_mfma_f32_32x32x16_bf16 v[96:111], v[148:151], v[128:131], v[96:111]
    v_exp_f32 v77, v77
    v_exp_f32 v78, v78
    v_exp_f32 v79, v79
    v_cvt_pk_bf16_f32 v132, v72, v73
    v_cvt_pk_bf16_f32 v133, v74, v75
    v_cvt_pk_bf16_f32 v134, v76, v77
    v_cvt_pk_bf16_f32 v135, v78, v79
    v_exp_f32 v80, v80
    v_exp_f32 v81, v81
    v_mfma_f32_32x32x16_bf16 v[96:111], v[152:155], v[132:135], v[96:111]
    s_waitcnt lgkmcnt(0)
    v_exp_f32 v82, v82
    v_exp_f32 v83, v83
    v_exp_f32 v84, v84
    v_mfma_f32_32x32x16_bf16 v[64:79], v[142:145], v[8:11], 0
    ds_read_b128 v[136:139], v4 offset:5184
    v_exp_f32 v85, v85
    v_exp_f32 v86, v86
    v_exp_f32 v87, v87
    v_cvt_pk_bf16_f32 v128, v80, v81
    v_cvt_pk_bf16_f32 v129, v82, v83
    v_cvt_pk_bf16_f32 v130, v84, v85
    v_cvt_pk_bf16_f32 v131, v86, v87
    v_mfma_f32_32x32x8_bf16 v[64:79], v[146:147], v[12:13], v[64:79]
    v_exp_f32 v88, v88
    v_exp_f32 v89, v89
    v_exp_f32 v90, v90
    v_exp_f32 v91, v91
    v_exp_f32 v92, v92
    v_mfma_f32_32x32x16_bf16 v[112:127], v[148:151], v[128:131], v[112:127]
    ds_read_b64 v[140:141], v172 offset:5184
    v_exp_f32 v93, v93
    v_exp_f32 v94, v94
    v_exp_f32 v95, v95
    v_cvt_pk_bf16_f32 v132, v88, v89
    v_cvt_pk_bf16_f32 v133, v90, v91
    v_cvt_pk_bf16_f32 v134, v92, v93
    v_cvt_pk_bf16_f32 v135, v94, v95
    v_exp_f32 v64, v64
    v_exp_f32 v65, v65
    v_mfma_f32_32x32x16_bf16 v[112:127], v[152:155], v[132:135], v[112:127]
    ds_read_b128 v[148:151], v168 offset:5184
    v_exp_f32 v66, v66
    v_exp_f32 v67, v67
    v_exp_f32 v68, v68
    v_mfma_f32_32x32x16_bf16 v[80:95], v[142:145], v[14:17], 0
    ds_read_b128 v[152:155], v169 offset:5184
    v_exp_f32 v69, v69
    v_exp_f32 v70, v70
    v_exp_f32 v71, v71
    v_cvt_pk_bf16_f32 v128, v64, v65
    v_cvt_pk_bf16_f32 v129, v66, v67
    v_cvt_pk_bf16_f32 v130, v68, v69
    v_cvt_pk_bf16_f32 v131, v70, v71
    v_mfma_f32_32x32x8_bf16 v[80:95], v[146:147], v[18:19], v[80:95]
    v_exp_f32 v72, v72
    v_exp_f32 v73, v73
    v_exp_f32 v74, v74
    v_exp_f32 v75, v75
    v_exp_f32 v76, v76
    v_mfma_f32_32x32x16_bf16 v[96:111], v[156:159], v[128:131], v[96:111]
    v_exp_f32 v77, v77
    v_exp_f32 v78, v78
    v_exp_f32 v79, v79
    v_cvt_pk_bf16_f32 v132, v72, v73
    v_cvt_pk_bf16_f32 v133, v74, v75
    v_cvt_pk_bf16_f32 v134, v76, v77
    v_cvt_pk_bf16_f32 v135, v78, v79
    v_exp_f32 v80, v80
    v_exp_f32 v81, v81
    v_mfma_f32_32x32x16_bf16 v[96:111], v[160:163], v[132:135], v[96:111]
    s_waitcnt lgkmcnt(0)
    v_exp_f32 v82, v82
    v_exp_f32 v83, v83
    v_exp_f32 v84, v84
    v_mfma_f32_32x32x16_bf16 v[64:79], v[136:139], v[8:11], 0
    ds_read_b128 v[142:145], v4 offset:7744
    v_exp_f32 v85, v85
    v_exp_f32 v86, v86
    v_exp_f32 v87, v87
    v_cvt_pk_bf16_f32 v128, v80, v81
    v_cvt_pk_bf16_f32 v129, v82, v83
    v_cvt_pk_bf16_f32 v130, v84, v85
    v_cvt_pk_bf16_f32 v131, v86, v87
    v_mfma_f32_32x32x8_bf16 v[64:79], v[140:141], v[12:13], v[64:79]
    v_exp_f32 v88, v88
    v_exp_f32 v89, v89
    v_exp_f32 v90, v90
    v_exp_f32 v91, v91
    v_exp_f32 v92, v92
    v_mfma_f32_32x32x16_bf16 v[112:127], v[156:159], v[128:131], v[112:127]
    ds_read_b64 v[146:147], v173 offset:5184
    v_exp_f32 v93, v93
    v_exp_f32 v94, v94
    v_exp_f32 v95, v95
    v_cvt_pk_bf16_f32 v132, v88, v89
    v_cvt_pk_bf16_f32 v133, v90, v91
    v_cvt_pk_bf16_f32 v134, v92, v93
    v_cvt_pk_bf16_f32 v135, v94, v95
    v_exp_f32 v64, v64
    v_exp_f32 v65, v65
    v_mfma_f32_32x32x16_bf16 v[112:127], v[160:163], v[132:135], v[112:127]
    ds_read_b128 v[156:159], v170 offset:5184
    v_exp_f32 v66, v66
    v_exp_f32 v67, v67
    v_exp_f32 v68, v68
    v_mfma_f32_32x32x16_bf16 v[80:95], v[136:139], v[14:17], 0
    ds_read_b128 v[160:163], v171 offset:5184
    v_exp_f32 v69, v69
    v_exp_f32 v70, v70
    v_exp_f32 v71, v71
    v_cvt_pk_bf16_f32 v128, v64, v65
    v_cvt_pk_bf16_f32 v129, v66, v67
    v_cvt_pk_bf16_f32 v130, v68, v69
    v_cvt_pk_bf16_f32 v131, v70, v71
    v_mfma_f32_32x32x8_bf16 v[80:95], v[140:141], v[18:19], v[80:95]
    v_exp_f32 v72, v72
    v_exp_f32 v73, v73
    v_exp_f32 v74, v74
    v_exp_f32 v75, v75
    v_exp_f32 v76, v76
    v_mfma_f32_32x32x16_bf16 v[96:111], v[148:151], v[128:131], v[96:111]
    v_exp_f32 v77, v77
    v_exp_f32 v78, v78
    v_exp_f32 v79, v79
    v_cvt_pk_bf16_f32 v132, v72, v73
    v_cvt_pk_bf16_f32 v133, v74, v75
    v_cvt_pk_bf16_f32 v134, v76, v77
    v_cvt_pk_bf16_f32 v135, v78, v79
    v_exp_f32 v80, v80
    v_exp_f32 v81, v81
    v_mfma_f32_32x32x16_bf16 v[96:111], v[152:155], v[132:135], v[96:111]
    s_waitcnt lgkmcnt(0)
    v_exp_f32 v82, v82
    v_exp_f32 v83, v83
    v_exp_f32 v84, v84
    v_mfma_f32_32x32x16_bf16 v[64:79], v[142:145], v[8:11], 0
    ds_read_b128 v[136:139], v4 offset:10368
    v_exp_f32 v85, v85
    v_exp_f32 v86, v86
    v_exp_f32 v87, v87
    v_cvt_pk_bf16_f32 v128, v80, v81
    v_cvt_pk_bf16_f32 v129, v82, v83
    v_cvt_pk_bf16_f32 v130, v84, v85
    v_cvt_pk_bf16_f32 v131, v86, v87
    v_mfma_f32_32x32x8_bf16 v[64:79], v[146:147], v[12:13], v[64:79]
    v_exp_f32 v88, v88
    v_exp_f32 v89, v89
    v_exp_f32 v90, v90
    v_exp_f32 v91, v91
    v_exp_f32 v92, v92
    v_mfma_f32_32x32x16_bf16 v[112:127], v[148:151], v[128:131], v[112:127]
    ds_read_b64 v[140:141], v172 offset:10368
    v_exp_f32 v93, v93
    v_exp_f32 v94, v94
    v_exp_f32 v95, v95
    v_cvt_pk_bf16_f32 v132, v88, v89
    v_cvt_pk_bf16_f32 v133, v90, v91
    v_cvt_pk_bf16_f32 v134, v92, v93
    v_cvt_pk_bf16_f32 v135, v94, v95
    v_exp_f32 v64, v64
    v_exp_f32 v65, v65
    v_mfma_f32_32x32x16_bf16 v[112:127], v[152:155], v[132:135], v[112:127]
    ds_read_b128 v[148:151], v168 offset:10368
    v_exp_f32 v66, v66
    v_exp_f32 v67, v67
    v_exp_f32 v68, v68
    v_mfma_f32_32x32x16_bf16 v[80:95], v[142:145], v[14:17], 0
    ds_read_b128 v[152:155], v169 offset:10368
    v_exp_f32 v69, v69
    v_exp_f32 v70, v70
    v_exp_f32 v71, v71
    v_cvt_pk_bf16_f32 v128, v64, v65
    v_cvt_pk_bf16_f32 v129, v66, v67
    v_cvt_pk_bf16_f32 v130, v68, v69
    v_cvt_pk_bf16_f32 v131, v70, v71
    v_mfma_f32_32x32x8_bf16 v[80:95], v[146:147], v[18:19], v[80:95]
    v_exp_f32 v72, v72
    v_exp_f32 v73, v73
    v_exp_f32 v74, v74
    v_exp_f32 v75, v75
    v_exp_f32 v76, v76
    v_mfma_f32_32x32x16_bf16 v[96:111], v[156:159], v[128:131], v[96:111]
    v_exp_f32 v77, v77
    v_exp_f32 v78, v78
    v_exp_f32 v79, v79
    v_cvt_pk_bf16_f32 v132, v72, v73
    v_cvt_pk_bf16_f32 v133, v74, v75
    v_cvt_pk_bf16_f32 v134, v76, v77
    v_cvt_pk_bf16_f32 v135, v78, v79
    v_exp_f32 v80, v80
    v_exp_f32 v81, v81
    v_mfma_f32_32x32x16_bf16 v[96:111], v[160:163], v[132:135], v[96:111]
    s_waitcnt lgkmcnt(0)
    v_exp_f32 v82, v82
    v_exp_f32 v83, v83
    v_exp_f32 v84, v84
    v_mfma_f32_32x32x16_bf16 v[64:79], v[136:139], v[8:11], 0
    ds_read_b128 v[142:145], v4 offset:12928
    v_exp_f32 v85, v85
    v_exp_f32 v86, v86
    v_exp_f32 v87, v87
    v_cvt_pk_bf16_f32 v128, v80, v81
    v_cvt_pk_bf16_f32 v129, v82, v83
    v_cvt_pk_bf16_f32 v130, v84, v85
    v_cvt_pk_bf16_f32 v131, v86, v87
    v_mfma_f32_32x32x8_bf16 v[64:79], v[140:141], v[12:13], v[64:79]
    v_exp_f32 v88, v88
    v_exp_f32 v89, v89
    v_exp_f32 v90, v90
    v_exp_f32 v91, v91
    v_exp_f32 v92, v92
    v_mfma_f32_32x32x16_bf16 v[112:127], v[156:159], v[128:131], v[112:127]
    ds_read_b64 v[146:147], v173 offset:10368
    v_exp_f32 v93, v93
    v_exp_f32 v94, v94
    v_exp_f32 v95, v95
    v_cvt_pk_bf16_f32 v132, v88, v89
    v_cvt_pk_bf16_f32 v133, v90, v91
    v_cvt_pk_bf16_f32 v134, v92, v93
    v_cvt_pk_bf16_f32 v135, v94, v95
    v_exp_f32 v64, v64
    v_exp_f32 v65, v65
    v_mfma_f32_32x32x16_bf16 v[112:127], v[160:163], v[132:135], v[112:127]
    ds_read_b128 v[156:159], v170 offset:10368
    v_exp_f32 v66, v66
    v_exp_f32 v67, v67
    v_exp_f32 v68, v68
    v_mfma_f32_32x32x16_bf16 v[80:95], v[136:139], v[14:17], 0
    ds_read_b128 v[160:163], v171 offset:10368
    v_exp_f32 v69, v69
    v_exp_f32 v70, v70
    v_exp_f32 v71, v71
    v_cvt_pk_bf16_f32 v128, v64, v65
    v_cvt_pk_bf16_f32 v129, v66, v67
    v_cvt_pk_bf16_f32 v130, v68, v69
    v_cvt_pk_bf16_f32 v131, v70, v71
    v_mfma_f32_32x32x8_bf16 v[80:95], v[140:141], v[18:19], v[80:95]
    v_exp_f32 v72, v72
    v_exp_f32 v73, v73
    v_exp_f32 v74, v74
    v_exp_f32 v75, v75
    v_exp_f32 v76, v76
    v_mfma_f32_32x32x16_bf16 v[96:111], v[148:151], v[128:131], v[96:111]
    v_exp_f32 v77, v77
    v_exp_f32 v78, v78
    v_exp_f32 v79, v79
    v_cvt_pk_bf16_f32 v132, v72, v73
    v_cvt_pk_bf16_f32 v133, v74, v75
    v_cvt_pk_bf16_f32 v134, v76, v77
    v_cvt_pk_bf16_f32 v135, v78, v79
    v_exp_f32 v80, v80
    v_exp_f32 v81, v81
    v_mfma_f32_32x32x16_bf16 v[96:111], v[152:155], v[132:135], v[96:111]
    s_waitcnt lgkmcnt(0)
    v_exp_f32 v82, v82
    v_exp_f32 v83, v83
    v_exp_f32 v84, v84
    v_mfma_f32_32x32x16_bf16 v[64:79], v[142:145], v[8:11], 0
    ds_read_b128 v[136:139], v4 offset:15552
    v_exp_f32 v85, v85
    v_exp_f32 v86, v86
    v_exp_f32 v87, v87
    v_cvt_pk_bf16_f32 v128, v80, v81
    v_cvt_pk_bf16_f32 v129, v82, v83
    v_cvt_pk_bf16_f32 v130, v84, v85
    v_cvt_pk_bf16_f32 v131, v86, v87
    v_mfma_f32_32x32x8_bf16 v[64:79], v[146:147], v[12:13], v[64:79]
    v_exp_f32 v88, v88
    v_exp_f32 v89, v89
    v_exp_f32 v90, v90
    v_exp_f32 v91, v91
    v_exp_f32 v92, v92
    v_mfma_f32_32x32x16_bf16 v[112:127], v[148:151], v[128:131], v[112:127]
    ds_read_b64 v[140:141], v172 offset:15552
    v_exp_f32 v93, v93
    v_exp_f32 v94, v94
    v_exp_f32 v95, v95
    v_cvt_pk_bf16_f32 v132, v88, v89
    v_cvt_pk_bf16_f32 v133, v90, v91
    v_cvt_pk_bf16_f32 v134, v92, v93
    v_cvt_pk_bf16_f32 v135, v94, v95
    v_exp_f32 v64, v64
    v_exp_f32 v65, v65
    v_mfma_f32_32x32x16_bf16 v[112:127], v[152:155], v[132:135], v[112:127]
    ds_read_b128 v[148:151], v168 offset:15552
    v_exp_f32 v66, v66
    v_exp_f32 v67, v67
    v_exp_f32 v68, v68
    v_mfma_f32_32x32x16_bf16 v[80:95], v[142:145], v[14:17], 0
    ds_read_b128 v[152:155], v169 offset:15552
    v_exp_f32 v69, v69
    v_exp_f32 v70, v70
    v_exp_f32 v71, v71
    v_cvt_pk_bf16_f32 v128, v64, v65
    v_cvt_pk_bf16_f32 v129, v66, v67
    v_cvt_pk_bf16_f32 v130, v68, v69
    v_cvt_pk_bf16_f32 v131, v70, v71
    v_mfma_f32_32x32x8_bf16 v[80:95], v[146:147], v[18:19], v[80:95]
    v_exp_f32 v72, v72
    v_exp_f32 v73, v73
    v_exp_f32 v74, v74
    v_exp_f32 v75, v75
    v_exp_f32 v76, v76
    v_mfma_f32_32x32x16_bf16 v[96:111], v[156:159], v[128:131], v[96:111]
    s_sub_u32 s46, s46, 1
    v_exp_f32 v77, v77
    v_exp_f32 v78, v78
    v_exp_f32 v79, v79
    v_cvt_pk_bf16_f32 v132, v72, v73
    v_cvt_pk_bf16_f32 v133, v74, v75
    v_cvt_pk_bf16_f32 v134, v76, v77
    v_cvt_pk_bf16_f32 v135, v78, v79
    v_exp_f32 v80, v80
    v_exp_f32 v81, v81
    v_mfma_f32_32x32x16_bf16 v[96:111], v[160:163], v[132:135], v[96:111]
    s_waitcnt lgkmcnt(0)
    v_exp_f32 v82, v82
    v_exp_f32 v83, v83
    v_exp_f32 v84, v84
    v_mfma_f32_32x32x16_bf16 v[64:79], v[136:139], v[8:11], 0
    ds_read_b128 v[142:145], v4 offset:18112
    v_exp_f32 v85, v85
    v_exp_f32 v86, v86
    v_exp_f32 v87, v87
    v_cvt_pk_bf16_f32 v128, v80, v81
    v_cvt_pk_bf16_f32 v129, v82, v83
    v_cvt_pk_bf16_f32 v130, v84, v85
    v_cvt_pk_bf16_f32 v131, v86, v87
    v_mfma_f32_32x32x8_bf16 v[64:79], v[140:141], v[12:13], v[64:79]
    v_exp_f32 v88, v88
    v_exp_f32 v89, v89
    v_exp_f32 v90, v90
    v_exp_f32 v91, v91
    v_exp_f32 v92, v92
    v_mfma_f32_32x32x16_bf16 v[112:127], v[156:159], v[128:131], v[112:127]
    ds_read_b64 v[146:147], v173 offset:15552
    v_exp_f32 v93, v93
    v_exp_f32 v94, v94
    v_exp_f32 v95, v95
    v_cvt_pk_bf16_f32 v132, v88, v89
    v_cvt_pk_bf16_f32 v133, v90, v91
    v_cvt_pk_bf16_f32 v134, v92, v93
    v_cvt_pk_bf16_f32 v135, v94, v95
    v_exp_f32 v64, v64
    v_exp_f32 v65, v65
    v_mfma_f32_32x32x16_bf16 v[112:127], v[160:163], v[132:135], v[112:127]
    ds_read_b128 v[156:159], v170 offset:15552
    v_exp_f32 v66, v66
    v_exp_f32 v67, v67
    v_exp_f32 v68, v68
    v_mfma_f32_32x32x16_bf16 v[80:95], v[136:139], v[14:17], 0
    ds_read_b128 v[160:163], v171 offset:15552
    v_exp_f32 v69, v69
    v_exp_f32 v70, v70
    v_exp_f32 v71, v71
    v_cvt_pk_bf16_f32 v128, v64, v65
    v_cvt_pk_bf16_f32 v129, v66, v67
    v_cvt_pk_bf16_f32 v130, v68, v69
    v_cvt_pk_bf16_f32 v131, v70, v71
    v_mfma_f32_32x32x8_bf16 v[80:95], v[140:141], v[18:19], v[80:95]
    v_exp_f32 v72, v72
    v_exp_f32 v73, v73
    v_exp_f32 v74, v74
    v_exp_f32 v75, v75
    v_exp_f32 v76, v76
    v_mfma_f32_32x32x16_bf16 v[96:111], v[148:151], v[128:131], v[96:111]
    ds_read_b32 v164, v23
    v_exp_f32 v77, v77
    v_exp_f32 v78, v78
    v_exp_f32 v79, v79
    v_cvt_pk_bf16_f32 v132, v72, v73
    v_cvt_pk_bf16_f32 v133, v74, v75
    v_cvt_pk_bf16_f32 v134, v76, v77
    v_cvt_pk_bf16_f32 v135, v78, v79
    v_add_u32 v4, 20736, v4
    v_add_u32 v168, 20736, v168
    v_add_u32 v169, 20736, v169
    v_add_u32 v170, 20736, v170
    v_add_u32 v171, 20736, v171
    v_add_u32 v172, 20736, v172
    v_add_u32 v173, 20736, v173
    s_cmp_eq_u32 s46, 0
    s_cbranch_scc1 L_attn_last
    s_cmp_lg_u32 s44, 16
    s_cbranch_scc1 L_attn_loop
.p2align 3
L_attn_fast:
    v_exp_f32 v80, v80
    v_exp_f32 v81, v81
    v_mfma_f32_32x32x16_bf16 v[96:111], v[152:155], v[132:135], v[96:111]
    s_waitcnt lgkmcnt(0)
    v_exp_f32 v82, v82
    v_exp_f32 v83, v83
    v_exp_f32 v84, v84
    v_mfma_f32_32x32x16_bf16 v[64:79], v[142:145], v[8:11], 0
    ds_read_b128 v[136:139], v4 offset:0
    v_exp_f32 v85, v85
    v_exp_f32 v86, v86
    v_exp_f32 v87, v87
    v_cvt_pk_bf16_f32 v128, v80, v81
    v_cvt_pk_bf16_f32 v129, v82, v83
    v_cvt_pk_bf16_f32 v130, v84, v85
    v_cvt_pk_bf16_f32 v131, v86, v87
    v_mfma_f32_32x32x8_bf16 v[64:79], v[146:147], v[12:13], v[64:79]
    v_exp_f32 v88, v88
    v_exp_f32 v89, v89
    v_exp_f32 v90, v90
    v_exp_f32 v91, v91
    v_exp_f32 v92, v92
    v_mfma_f32_32x32x16_bf16 v[112:127], v[148:151], v[128:131], v[112:127]
    ds_read_b64 v[140:141], v172 offset:0
    v_exp_f32 v93, v93
    v_exp_f32 v94, v94
    v_exp_f32 v95, v95
    v_cvt_pk_bf16_f32 v132, v88, v89
    v_cvt_pk_bf16_f32 v133, v90, v91
    v_cvt_pk_bf16_f32 v134, v92, v93
    v_cvt_pk_bf16_f32 v135, v94, v95
    v_exp_f32 v64, v64
    v_exp_f32 v65, v65
    v_mfma_f32_32x32x16_bf16 v[112:127], v[152:155], v[132:135], v[112:127]
    ds_read_b128 v[148:151], v168 offset:0
    v_exp_f32 v66, v66
    v_exp_f32 v67, v67
    v_exp_f32 v68, v68
    v_mfma_f32_32x32x16_bf16 v[80:95], v[142:145], v[14:17], 0
    ds_read_b128 v[152:155], v169 offset:0
    v_exp_f32 v69, v69
    v_exp_f32 v70, v70
    v_exp_f32 v71, v71
    v_cvt_pk_bf16_f32 v128, v64, v65
    v_cvt_pk_bf16_f32 v129, v66, v67
    v_cvt_pk_bf16_f32 v130, v68, v69
    v_cvt_pk_bf16_f32 v131, v70, v71
    v_mfma_f32_32x32x8_bf16 v[80:95], v[146:147], v[18:19], v[80:95]
    v_exp_f32 v72, v72
    v_exp_f32 v73, v73
    v_exp_f32 v74, v74
    v_exp_f32 v75, v75
    v_exp_f32 v76, v76
    v_mfma_f32_32x32x16_bf16 v[96:111], v[156:159], v[128:131], v[96:111]
    v_exp_f32 v77, v77
    v_exp_f32 v78, v78
    v_exp_f32 v79, v79
    v_cvt_pk_bf16_f32 v132, v72, v73
    v_cvt_pk_bf16_f32 v133, v74, v75
    v_cvt_pk_bf16_f32 v134, v76, v77
    v_cvt_pk_bf16_f32 v135, v78, v79
    v_exp_f32 v80, v80
    v_exp_f32 v81, v81
    v_mfma_f32_32x32x16_bf16 v[96:111], v[160:163], v[132:135], v[96:111]
    s_waitcnt lgkmcnt(0)
    v_exp_f32 v82, v82
    v_exp_f32 v83, v83
    v_exp_f32 v84, v84
    v_mfma_f32_32x32x16_bf16 v[64:79], v[136:139], v[8:11], 0
    ds_read_b128 v[142:145], v4 offset:2560
    v_exp_f32 v85, v85
    v_exp_f32 v86, v86
    v_exp_f32 v87, v87
    v_cvt_pk_bf16_f32 v128, v80, v81
    v_cvt_pk_bf16_f32 v129, v82, v83
    v_cvt_pk_bf16_f32 v130, v84, v85
    v_cvt_pk_bf16_f32 v131, v86, v87
    v_mfma_f32_32x32x8_bf16 v[64:79], v[140:141], v[12:13], v[64:79]
    v_exp_f32 v88, v88
    v_exp_f32 v89, v89
    v_exp_f32 v90, v90
    v_exp_f32 v91, v91
    v_exp_f32 v92, v92
    v_mfma_f32_32x32x16_bf16 v[112:127], v[156:159], v[128:131], v[112:127]
    ds_read_b64 v[146:147], v173 offset:0
    v_exp_f32 v93, v93
    v_exp_f32 v94, v94
    v_exp_f32 v95, v95
    v_cvt_pk_bf16_f32 v132, v88, v89
    v_cvt_pk_bf16_f32 v133, v90, v91
    v_cvt_pk_bf16_f32 v134, v92, v93
    v_cvt_pk_bf16_f32 v135, v94, v95
    v_exp_f32 v64, v64
    v_exp_f32 v65, v65
    v_mfma_f32_32x32x16_bf16 v[112:127], v[160:163], v[132:135], v[112:127]
    ds_read_b128 v[156:159], v170 offset:0
    v_exp_f32 v66, v66
    v_exp_f32 v67, v67
    v_exp_f32 v68, v68
    v_mfma_f32_32x32x16_bf16 v[80:95], v[136:139], v[14:17], 0
    ds_read_b128 v[160:163], v171 offset:0
    v_exp_f32 v69, v69
    v_exp_f32 v70, v70
    v_exp_f32 v71, v71
    v_cvt_pk_bf16_f32 v128, v64, v65
    v_cvt_pk_bf16_f32 v129, v66, v67
    v_cvt_pk_bf16_f32 v130, v68, v69
    v_cvt_pk_bf16_f32 v131, v70, v71
    v_mfma_f32_32x32x8_bf16 v[80:95], v[140:141], v[18:19], v[80:95]
    v_exp_f32 v72, v72
    v_exp_f32 v73, v73
    v_exp_f32 v74, v74
    v_exp_f32 v75, v75
    v_exp_f32 v76, v76
    v_mfma_f32_32x32x16_bf16 v[96:111], v[148:151], v[128:131], v[96:111]
    v_exp_f32 v77, v77
    v_exp_f32 v78, v78
    v_exp_f32 v79, v79
    v_cvt_pk_bf16_f32 v132, v72, v73
    v_cvt_pk_bf16_f32 v133, v74, v75
    v_cvt_pk_bf16_f32 v134, v76, v77
    v_cvt_pk_bf16_f32 v135, v78, v79
    v_exp_f32 v80, v80
    v_exp_f32 v81, v81
    v_mfma_f32_32x32x16_bf16 v[96:111], v[152:155], v[132:135], v[96:111]
    s_waitcnt lgkmcnt(0)
    v_exp_f32 v82, v82
    v_exp_f32 v83, v83
    v_exp_f32 v84, v84
    v_mfma_f32_32x32x16_bf16 v[64:79], v[142:145], v[8:11], 0
    ds_read_b128 v[136:139], v4 offset:5184
    v_exp_f32 v85, v85
    v_exp_f32 v86, v86
    v_exp_f32 v87, v87
    v_cvt_pk_bf16_f32 v128, v80, v81
    v_cvt_pk_bf16_f32 v129, v82, v83
    v_cvt_pk_bf16_f32 v130, v84, v85
    v_cvt_pk_bf16_f32 v131, v86, v87
    v_mfma_f32_32x32x8_bf16 v[64:79], v[146:147], v[12:13], v[64:79]
    v_exp_f32 v88, v88
    v_exp_f32 v89, v89
    v_exp_f32 v90, v90
    v_exp_f32 v91, v91
    v_exp_f32 v92, v92
    v_mfma_f32_32x32x16_bf16 v[112:127], v[148:151], v[128:131], v[112:127]
    ds_read_b64 v[140:141], v172 offset:5184
    v_exp_f32 v93, v93
    v_exp_f32 v94, v94
    v_exp_f32 v95, v95
    v_cvt_pk_bf16_f32 v132, v88, v89
    v_cvt_pk_bf16_f32 v133, v90, v91
    v_cvt_pk_bf16_f32 v134, v92, v93
    v_cvt_pk_bf16_f32 v135, v94, v95
    v_exp_f32 v64, v64
    v_exp_f32 v65, v65
    v_mfma_f32_32x32x16_bf16 v[112:127], v[152:155], v[132:135], v[112:127]
    ds_read_b128 v[148:151], v168 offset:5184
    v_exp_f32 v66, v66
    v_exp_f32 v67, v67
    v_exp_f32 v68, v68
    v_mfma_f32_32x32x16_bf16 v[80:95], v[142:145], v[14:17], 0
    ds_read_b128 v[152:155], v169 offset:5184
    v_exp_f32 v69, v69
    v_exp_f32 v70, v70
    v_exp_f32 v71, v71
    v_cvt_pk_bf16_f32 v128, v64, v65
    v_cvt_pk_bf16_f32 v129, v66, v67
    v_cvt_pk_bf16_f32 v130, v68, v69
    v_cvt_pk_bf16_f32 v131, v70, v71
    v_mfma_f32_32x32x8_bf16 v[80:95], v[146:147], v[18:19], v[80:95]
    v_exp_f32 v72, v72
    v_exp_f32 v73, v73
    v_exp_f32 v74, v74
    v_exp_f32 v75, v75
    v_exp_f32 v76, v76
    v_mfma_f32_32x32x16_bf16 v[96:111], v[156:159], v[128:131], v[96:111]
    v_exp_f32 v77, v77
    v_exp_f32 v78, v78
    v_exp_f32 v79, v79
    v_cvt_pk_bf16_f32 v132, v72, v73
    v_cvt_pk_bf16_f32 v133, v74, v75
    v_cvt_pk_bf16_f32 v134, v76, v77
    v_cvt_pk_bf16_f32 v135, v78, v79
    v_exp_f32 v80, v80
    v_exp_f32 v81, v81
    v_mfma_f32_32x32x16_bf16 v[96:111], v[160:163], v[132:135], v[96:111]
    s_waitcnt lgkmcnt(0)
    v_exp_f32 v82, v82
    v_exp_f32 v83, v83
    v_exp_f32 v84, v84
    v_mfma_f32_32x32x16_bf16 v[64:79], v[136:139], v[8:11], 0
    ds_read_b128 v[142:145], v4 offset:7744
    v_exp_f32 v85, v85
    v_exp_f32 v86, v86
    v_exp_f32 v87, v87
    v_cvt_pk_bf16_f32 v128, v80, v81
    v_cvt_pk_bf16_f32 v129, v82, v83
    v_cvt_pk_bf16_f32 v130, v84, v85
    v_cvt_pk_bf16_f32 v131, v86, v87
    v_mfma_f32_32x32x8_bf16 v[64:79], v[140:141], v[12:13], v[64:79]
    v_exp_f32 v88, v88
    v_exp_f32 v89, v89
    v_exp_f32 v90, v90
    v_exp_f32 v91, v91
    v_exp_f32 v92, v92
    v_mfma_f32_32x32x16_bf16 v[112:127], v[156:159], v[128:131], v[112:127]
    ds_read_b64 v[146:147], v173 offset:5184
    v_exp_f32 v93, v93
    v_exp_f32 v94, v94
    v_exp_f32 v95, v95
    v_cvt_pk_bf16_f32 v132, v88, v89
    v_cvt_pk_bf16_f32 v133, v90, v91
    v_cvt_pk_bf16_f32 v134, v92, v93
    v_cvt_pk_bf16_f32 v135, v94, v95
    v_exp_f32 v64, v64
    v_exp_f32 v65, v65
    v_mfma_f32_32x32x16_bf16 v[112:127], v[160:163], v[132:135], v[112:127]
    ds_read_b128 v[156:159], v170 offset:5184
    v_exp_f32 v66, v66
    v_exp_f32 v67, v67
    v_exp_f32 v68, v68
    v_mfma_f32_32x32x16_bf16 v[80:95], v[136:139], v[14:17], 0
    ds_read_b128 v[160:163], v171 offset:5184
    v_exp_f32 v69, v69
    v_exp_f32 v70, v70
    v_exp_f32 v71, v71
    v_cvt_pk_bf16_f32 v128, v64, v65
    v_cvt_pk_bf16_f32 v129, v66, v67
    v_cvt_pk_bf16_f32 v130, v68, v69
    v_cvt_pk_bf16_f32 v131, v70, v71
    v_mfma_f32_32x32x8_bf16 v[80:95], v[140:141], v[18:19], v[80:95]
    v_exp_f32 v72, v72
    v_exp_f32 v73, v73
    v_exp_f32 v74, v74
    v_exp_f32 v75, v75
    v_exp_f32 v76, v76
    v_mfma_f32_32x32x16_bf16 v[96:111], v[148:151], v[128:131], v[96:111]
    v_exp_f32 v77, v77
    v_exp_f32 v78, v78
    v_exp_f32 v79, v79
    v_cvt_pk_bf16_f32 v132, v72, v73
    v_cvt_pk_bf16_f32 v133, v74, v75
    v_cvt_pk_bf16_f32 v134, v76, v77
    v_cvt_pk_bf16_f32 v135, v78, v79
    v_exp_f32 v80, v80
    v_exp_f32 v81, v81
    v_mfma_f32_32x32x16_bf16 v[96:111], v[152:155], v[132:135], v[96:111]
    s_waitcnt lgkmcnt(0)
    v_exp_f32 v82, v82
    v_exp_f32 v83, v83
    v_exp_f32 v84, v84
    v_mfma_f32_32x32x16_bf16 v[64:79], v[142:145], v[8:11], 0
    ds_read_b128 v[136:139], v4 offset:10368
    v_exp_f32 v85, v85
    v_exp_f32 v86, v86
    v_exp_f32 v87, v87
    v_cvt_pk_bf16_f32 v128, v80, v81
    v_cvt_pk_bf16_f32 v129, v82, v83
    v_cvt_pk_bf16_f32 v130, v84, v85
    v_cvt_pk_bf16_f32 v131, v86, v87
    v_mfma_f32_32x32x8_bf16 v[64:79], v[146:147], v[12:13], v[64:79]
    v_exp_f32 v88, v88
    v_exp_f32 v89, v89
    v_exp_f32 v90, v90
    v_exp_f32 v91, v91
    v_exp_f32 v92, v92
    v_mfma_f32_32x32x16_bf16 v[112:127], v[148:151], v[128:131], v[112:127]
    ds_read_b64 v[140:141], v172 offset:10368
    v_exp_f32 v93, v93
    v_exp_f32 v94, v94
    v_exp_f32 v95, v95
    v_cvt_pk_bf16_f32 v132, v88, v89
    v_cvt_pk_bf16_f32 v133, v90, v91
    v_cvt_pk_bf16_f32 v134, v92, v93
    v_cvt_pk_bf16_f32 v135, v94, v95
    v_exp_f32 v64, v64
    v_exp_f32 v65, v65
    v_mfma_f32_32x32x16_bf16 v[112:127], v[152:155], v[132:135], v[112:127]
    ds_read_b128 v[148:151], v168 offset:10368
    v_exp_f32 v66, v66
    v_exp_f32 v67, v67
    v_exp_f32 v68, v68
    v_mfma_f32_32x32x16_bf16 v[80:95], v[142:145], v[14:17], 0
    ds_read_b128 v[152:155], v169 offset:10368
    v_exp_f32 v69, v69
    v_exp_f32 v70, v70
    v_exp_f32 v71, v71
    v_cvt_pk_bf16_f32 v128, v64, v65
    v_cvt_pk_bf16_f32 v129, v66, v67
    v_cvt_pk_bf16_f32 v130, v68, v69
    v_cvt_pk_bf16_f32 v131, v70, v71
    v_mfma_f32_32x32x8_bf16 v[80:95], v[146:147], v[18:19], v[80:95]
    v_exp_f32 v72, v72
    v_exp_f32 v73, v73
    v_exp_f32 v74, v74
    v_exp_f32 v75, v75
    v_exp_f32 v76, v76
    v_mfma_f32_32x32x16_bf16 v[96:111], v[156:159], v[128:131], v[96:111]
    v_exp_f32 v77, v77
    v_exp_f32 v78, v78
    v_exp_f32 v79, v79
    v_cvt_pk_bf16_f32 v132, v72, v73
    v_cvt_pk_bf16_f32 v133, v74, v75
    v_cvt_pk_bf16_f32 v134, v76, v77
    v_cvt_pk_bf16_f32 v135, v78, v79
    v_exp_f32 v80, v80
    v_exp_f32 v81, v81
    v_mfma_f32_32x32x16_bf16 v[96:111], v[160:163], v[132:135], v[96:111]
    s_waitcnt lgkmcnt(0)
    v_exp_f32 v82, v82
    v_exp_f32 v83, v83
    v_exp_f32 v84, v84
    v_mfma_f32_32x32x16_bf16 v[64:79], v[136:139], v[8:11], 0
    ds_read_b128 v[142:145], v4 offset:12928
    v_exp_f32 v85, v85
    v_exp_f32 v86, v86
    v_exp_f32 v87, v87
    v_cvt_pk_bf16_f32 v128, v80, v81
    v_cvt_pk_bf16_f32 v129, v82, v83
    v_cvt_pk_bf16_f32 v130, v84, v85
    v_cvt_pk_bf16_f32 v131, v86, v87
    v_mfma_f32_32x32x8_bf16 v[64:79], v[140:141], v[12:13], v[64:79]
    v_exp_f32 v88, v88
    v_exp_f32 v89, v89
    v_exp_f32 v90, v90
    v_exp_f32 v91, v91
    v_exp_f32 v92, v92
    v_mfma_f32_32x32x16_bf16 v[112:127], v[156:159], v[128:131], v[112:127]
    ds_read_b64 v[146:147], v173 offset:10368
    v_exp_f32 v93, v93
    v_exp_f32 v94, v94
    v_exp_f32 v95, v95
    v_cvt_pk_bf16_f32 v132, v88, v89
    v_cvt_pk_bf16_f32 v133, v90, v91
    v_cvt_pk_bf16_f32 v134, v92, v93
    v_cvt_pk_bf16_f32 v135, v94, v95
    v_exp_f32 v64, v64
    v_exp_f32 v65, v65
    v_mfma_f32_32x32x16_bf16 v[112:127], v[160:163], v[132:135], v[112:127]
    ds_read_b128 v[156:159], v170 offset:10368
    v_exp_f32 v66, v66
    v_exp_f32 v67, v67
    v_exp_f32 v68, v68
    v_mfma_f32_32x32x16_bf16 v[80:95], v[136:139], v[14:17], 0
    ds_read_b128 v[160:163], v171 offset:10368
    v_exp_f32 v69, v69
    v_exp_f32 v70, v70
    v_exp_f32 v71, v71
    v_cvt_pk_bf16_f32 v128, v64, v65
    v_cvt_pk_bf16_f32 v129, v66, v67
    v_cvt_pk_bf16_f32 v130, v68, v69
    v_cvt_pk_bf16_f32 v131, v70, v71
    v_mfma_f32_32x32x8_bf16 v[80:95], v[140:141], v[18:19], v[80:95]
    v_exp_f32 v72, v72
    v_exp_f32 v73, v73
    v_exp_f32 v74, v74
    v_exp_f32 v75, v75
    v_exp_f32 v76, v76
    v_mfma_f32_32x32x16_bf16 v[96:111], v[148:151], v[128:131], v[96:111]
    v_exp_f32 v77, v77
    v_exp_f32 v78, v78
    v_exp_f32 v79, v79
    v_cvt_pk_bf16_f32 v132, v72, v73
    v_cvt_pk_bf16_f32 v133, v74, v75
    v_cvt_pk_bf16_f32 v134, v76, v77
    v_cvt_pk_bf16_f32 v135, v78, v79
    v_exp_f32 v80, v80
    v_exp_f32 v81, v81
    v_mfma_f32_32x32x16_bf16 v[96:111], v[152:155], v[132:135], v[96:111]
    s_waitcnt lgkmcnt(0)
    v_exp_f32 v82, v82
    v_exp_f32 v83, v83
    v_exp_f32 v84, v84
    v_mfma_f32_32x32x16_bf16 v[64:79], v[142:145], v[8:11], 0
    ds_read_b128 v[136:139], v4 offset:15552
    v_exp_f32 v85, v85
    v_exp_f32 v86, v86
    v_exp_f32 v87, v87
    v_cvt_pk_bf16_f32 v128, v80, v81
    v_cvt_pk_bf16_f32 v129, v82, v83
    v_cvt_pk_bf16_f32 v130, v84, v85
    v_cvt_pk_bf16_f32 v131, v86, v87
    v_mfma_f32_32x32x8_bf16 v[64:79], v[146:147], v[12:13], v[64:79]
    v_exp_f32 v88, v88
    v_exp_f32 v89, v89
    v_exp_f32 v90, v90
    v_exp_f32 v91, v91
    v_exp_f32 v92, v92
    v_mfma_f32_32x32x16_bf16 v[112:127], v[148:151], v[128:131], v[112:127]
    ds_read_b64 v[140:141], v172 offset:15552
    v_exp_f32 v93, v93
    v_exp_f32 v94, v94
    v_exp_f32 v95, v95
    v_cvt_pk_bf16_f32 v132, v88, v89
    v_cvt_pk_bf16_f32 v133, v90, v91
    v_cvt_pk_bf16_f32 v134, v92, v93
    v_cvt_pk_bf16_f32 v135, v94, v95
    v_exp_f32 v64, v64
    v_exp_f32 v65, v65
    v_mfma_f32_32x32x16_bf16 v[112:127], v[152:155], v[132:135], v[112:127]
    ds_read_b128 v[148:151], v168 offset:15552
    v_exp_f32 v66, v66
    v_exp_f32 v67, v67
    v_exp_f32 v68, v68
    v_mfma_f32_32x32x16_bf16 v[80:95], v[142:145], v[14:17], 0
    ds_read_b128 v[152:155], v169 offset:15552
    v_exp_f32 v69, v69
    v_exp_f32 v70, v70
    v_exp_f32 v71, v71
    v_cvt_pk_bf16_f32 v128, v64, v65
    v_cvt_pk_bf16_f32 v129, v66, v67
    v_cvt_pk_bf16_f32 v130, v68, v69
    v_cvt_pk_bf16_f32 v131, v70, v71
    v_mfma_f32_32x32x8_bf16 v[80:95], v[146:147], v[18:19], v[80:95]
    v_exp_f32 v72, v72
    v_exp_f32 v73, v73
    v_exp_f32 v74, v74
    v_exp_f32 v75, v75
    v_exp_f32 v76, v76
    v_mfma_f32_32x32x16_bf16 v[96:111], v[156:159], v[128:131], v[96:111]
    s_sub_u32 s46, s46, 1
    v_exp_f32 v77, v77
    v_exp_f32 v78, v78
    v_exp_f32 v79, v79
    v_cvt_pk_bf16_f32 v132, v72, v73
    v_cvt_pk_bf16_f32 v133, v74, v75
    v_cvt_pk_bf16_f32 v134, v76, v77
    v_cvt_pk_bf16_f32 v135, v78, v79
    v_exp_f32 v80, v80
    v_exp_f32 v81, v81
    v_mfma_f32_32x32x16_bf16 v[96:111], v[160:163], v[132:135], v[96:111]
    s_waitcnt lgkmcnt(0)
    v_exp_f32 v82, v82
    v_exp_f32 v83, v83
    v_exp_f32 v84, v84
    v_mfma_f32_32x32x16_bf16 v[64:79], v[136:139], v[8:11], 0
    ds_read_b128 v[142:145], v4 offset:18112
    v_exp_f32 v85, v85
    v_exp_f32 v86, v86
    v_exp_f32 v87, v87
    v_cvt_pk_bf16_f32 v128, v80, v81
    v_cvt_pk_bf16_f32 v129, v82, v83
    v_cvt_pk_bf16_f32 v130, v84, v85
    v_cvt_pk_bf16_f32 v131, v86, v87
    v_mfma_f32_32x32x8_bf16 v[64:79], v[140:141], v[12:13], v[64:79]
    v_exp_f32 v88, v88
    v_exp_f32 v89, v89
    v_exp_f32 v90, v90
    v_exp_f32 v91, v91
    v_exp_f32 v92, v92
    v_mfma_f32_32x32x16_bf16 v[112:127], v[156:159], v[128:131], v[112:127]
    ds_read_b64 v[146:147], v173 offset:15552
    v_exp_f32 v93, v93
    v_exp_f32 v94, v94
    v_exp_f32 v95, v95
    v_cvt_pk_bf16_f32 v132, v88, v89
    v_cvt_pk_bf16_f32 v133, v90, v91
    v_cvt_pk_bf16_f32 v134, v92, v93
    v_cvt_pk_bf16_f32 v135, v94, v95
    v_exp_f32 v64, v64
    v_exp_f32 v65, v65
    v_mfma_f32_32x32x16_bf16 v[112:127], v[160:163], v[132:135], v[112:127]
    ds_read_b128 v[156:159], v170 offset:15552
    v_exp_f32 v66, v66
    v_exp_f32 v67, v67
    v_exp_f32 v68, v68
    v_mfma_f32_32x32x16_bf16 v[80:95], v[136:139], v[14:17], 0
    ds_read_b128 v[160:163], v171 offset:15552
    v_exp_f32 v69, v69
    v_exp_f32 v70, v70
    v_exp_f32 v71, v71
    v_cvt_pk_bf16_f32 v128, v64, v65
    v_cvt_pk_bf16_f32 v129, v66, v67
    v_cvt_pk_bf16_f32 v130, v68, v69
    v_cvt_pk_bf16_f32 v131, v70, v71
    v_mfma_f32_32x32x8_bf16 v[80:95], v[140:141], v[18:19], v[80:95]
    v_exp_f32 v72, v72
    v_exp_f32 v73, v73
    v_exp_f32 v74, v74
    v_exp_f32 v75, v75
    v_exp_f32 v76, v76
    v_mfma_f32_32x32x16_bf16 v[96:111], v[148:151], v[128:131], v[96:111]
    s_cmp_lg_u32 s46, 0
    v_exp_f32 v77, v77
    v_exp_f32 v78, v78
    v_exp_f32 v79, v79
    v_cvt_pk_bf16_f32 v132, v72, v73
    v_cvt_pk_bf16_f32 v133, v74, v75
    v_cvt_pk_bf16_f32 v134, v76, v77
    v_cvt_pk_bf16_f32 v135, v78, v79
    v_add_u32 v4, 20736, v4
    v_add_u32 v168, 20736, v168
    v_add_u32 v169, 20736, v169
    v_add_u32 v170, 20736, v170
    v_add_u32 v171, 20736, v171
    v_add_u32 v172, 20736, v172
    v_add_u32 v173, 20736, v173
    s_cbranch_scc1 L_attn_fast
.p2align 3
L_attn_last:
    v_exp_f32 v80, v80
    v_exp_f32 v81, v81
    v_mfma_f32_32x32x16_bf16 v[96:111], v[152:155], v[132:135], v[96:111]
    s_waitcnt lgkmcnt(0)
    v_exp_f32 v82, v82
    v_exp_f32 v83, v83
    v_exp_f32 v84, v84
    v_mfma_f32_32x32x16_bf16 v[64:79], v[142:145], v[8:11], 0
    v_exp_f32 v85, v85
    v_exp_f32 v86, v86
    v_exp_f32 v87, v87
    v_cvt_pk_bf16_f32 v128, v80, v81
    v_cvt_pk_bf16_f32 v129, v82, v83
    v_cvt_pk_bf16_f32 v130, v84, v85
    v_cvt_pk_bf16_f32 v131, v86, v87
    v_mfma_f32_32x32x8_bf16 v[64:79], v[146:147], v[12:13], v[64:79]
    v_exp_f32 v88, v88
    v_exp_f32 v89, v89
    v_exp_f32 v90, v90
    v_exp_f32 v91, v91
    v_exp_f32 v92, v92
    v_mfma_f32_32x32x16_bf16 v[112:127], v[148:151], v[128:131], v[112:127]
    v_exp_f32 v93, v93
    v_exp_f32 v94, v94
    v_exp_f32 v95, v95
    v_cvt_pk_bf16_f32 v132, v88, v89
    v_cvt_pk_bf16_f32 v133, v90, v91
    v_cvt_pk_bf16_f32 v134, v92, v93
    v_cvt_pk_bf16_f32 v135, v94, v95
    v_exp_f32 v64, v64
    v_exp_f32 v65, v65
    v_mfma_f32_32x32x16_bf16 v[112:127], v[152:155], v[132:135], v[112:127]
    v_exp_f32 v66, v66
    v_exp_f32 v67, v67
    v_exp_f32 v68, v68
    v_mfma_f32_32x32x16_bf16 v[80:95], v[142:145], v[14:17], 0
    v_exp_f32 v69, v69
    v_exp_f32 v70, v70
    v_exp_f32 v71, v71
    v_cvt_pk_bf16_f32 v128, v64, v65
    v_cvt_pk_bf16_f32 v129, v66, v67
    v_cvt_pk_bf16_f32 v130, v68, v69
    v_cvt_pk_bf16_f32 v131, v70, v71
    v_mfma_f32_32x32x8_bf16 v[80:95], v[146:147], v[18:19], v[80:95]
    v_exp_f32 v72, v72
    v_exp_f32 v73, v73
    v_exp_f32 v74, v74
    v_exp_f32 v75, v75
    v_exp_f32 v76, v76
    v_mfma_f32_32x32x16_bf16 v[96:111], v[156:159], v[128:131], v[96:111]
    v_exp_f32 v77, v77
    v_exp_f32 v78, v78
    v_exp_f32 v79, v79
    v_cvt_pk_bf16_f32 v132, v72, v73
    v_cvt_pk_bf16_f32 v133, v74, v75
    v_cvt_pk_bf16_f32 v134, v76, v77
    v_cvt_pk_bf16_f32 v135, v78, v79
    v_exp_f32 v80, v80
    v_exp_f32 v81, v81
    v_mfma_f32_32x32x16_bf16 v[96:111], v[160:163], v[132:135], v[96:111]
    v_exp_f32 v82, v82
    v_exp_f32 v83, v83
    v_exp_f32 v84, v84
    v_exp_f32 v85, v85
    v_exp_f32 v86, v86
    v_exp_f32 v87, v87
    v_cvt_pk_bf16_f32 v128, v80, v81
    v_cvt_pk_bf16_f32 v129, v82, v83
    v_cvt_pk_bf16_f32 v130, v84, v85
    v_cvt_pk_bf16_f32 v131, v86, v87
    v_exp_f32 v88, v88
    v_exp_f32 v89, v89
    v_exp_f32 v90, v90
    v_exp_f32 v91, v91
    v_exp_f32 v92, v92
    v_mfma_f32_32x32x16_bf16 v[112:127], v[156:159], v[128:131], v[112:127]
    v_exp_f32 v93, v93
    v_exp_f32 v94, v94
    v_exp_f32 v95, v95
    v_cvt_pk_bf16_f32 v132, v88, v89
    v_cvt_pk_bf16_f32 v133, v90, v91
    v_cvt_pk_bf16_f32 v134, v92, v93
    v_cvt_pk_bf16_f32 v135, v94, v95
    s_nop 1
    v_mfma_f32_32x32x16_bf16 v[112:127], v[160:163], v[132:135], v[112:127]
L_attn_post:
    s_lshl_b32 s42, s41, 5
    s_add_u32 s42, s42, s26
    s_mul_i32 s42, s42, 1280
    v_lshlrev_b32 v21, 4, v1
    v_mov_b32 v24, v104
    v_mov_b32 v26, v104
    s_nop 1
    v_permlane32_swap_b32 v26, v24
    s_nop 0
    v_rcp_f32 v26, v24
    s_nop 0
    v_mul_f32 v64, v96, v26
    v_mul_f32 v65, v97, v26
    v_mul_f32 v66, v98, v26
    v_mul_f32 v67, v99, v26
    v_mul_f32 v68, v100, v26
    v_mul_f32 v69, v101, v26
    v_mul_f32 v70, v102, v26
    v_mul_f32 v71, v103, v26
    v_mul_f32 v72, v104, v26
    v_mul_f32 v73, v105, v26
    v_mul_f32 v74, v106, v26
    v_mul_f32 v75, v107, v26
    v_cvt_pk_bf16_f32 v64, v64, v65
    v_cvt_pk_bf16_f32 v65, v66, v67
    v_cvt_pk_bf16_f32 v66, v68, v69
    v_cvt_pk_bf16_f32 v67, v70, v71
    v_cvt_pk_bf16_f32 v68, v72, v73
    v_cvt_pk_bf16_f32 v69, v74, v75
    buffer_store_dwordx4 v[64:67], v21, s[36:39], s42 offen sc1
    buffer_store_dwordx2 v[68:69], v20, s[36:39], s42 offen sc1
    s_add_u32 s42, s42, 40960
    v_mov_b32 v25, v120
    v_mov_b32 v26, v120
    s_nop 1
    v_permlane32_swap_b32 v26, v25
    s_nop 0
    v_rcp_f32 v26, v25
    s_nop 0
    v_mul_f32 v80, v112, v26
    v_mul_f32 v81, v113, v26
    v_mul_f32 v82, v114, v26
    v_mul_f32 v83, v115, v26
    v_mul_f32 v84, v116, v26
    v_mul_f32 v85, v117, v26
    v_mul_f32 v86, v118, v26
    v_mul_f32 v87, v119, v26
    v_mul_f32 v88, v120, v26
    v_mul_f32 v89, v121, v26
    v_mul_f32 v90, v122, v26
    v_mul_f32 v91, v123, v26
    v_cvt_pk_bf16_f32 v80, v80, v81
    v_cvt_pk_bf16_f32 v81, v82, v83
    v_cvt_pk_bf16_f32 v82, v84, v85
    v_cvt_pk_bf16_f32 v83, v86, v87
    v_cvt_pk_bf16_f32 v84, v88, v89
    v_cvt_pk_bf16_f32 v85, v90, v91
    buffer_store_dwordx4 v[80:83], v21, s[36:39], s42 offen sc1
    buffer_store_dwordx2 v[84:85], v20, s[36:39], s42 offen sc1
    s_cmp_eq_u32 s46, 0
    s_cbranch_scc0 L_attn_fin
    v_max3_f32 v30, abs(v96), abs(v97), abs(v98)
    v_mul_f32 v26, 0, v24
    v_max3_f32 v31, abs(v112), abs(v113), abs(v114)
    v_mul_f32 v27, 0, v25
    v_fma_f32 v26, v96, 0, v26
    v_fma_f32 v27, v112, 0, v27
    v_fma_f32 v26, v97, 0, v26
    v_fma_f32 v27, v113, 0, v27
    v_fma_f32 v26, v98, 0, v26
    v_fma_f32 v27, v114, 0, v27
    v_fma_f32 v26, v99, 0, v26
    v_fma_f32 v27, v115, 0, v27
    v_fma_f32 v26, v100, 0, v26
    v_fma_f32 v27, v116, 0, v27
    v_fma_f32 v26, v101, 0, v26
    v_fma_f32 v27, v117, 0, v27
    v_fma_f32 v26, v102, 0, v26
    v_fma_f32 v27, v118, 0, v27
    v_fma_f32 v26, v103, 0, v26
    v_fma_f32 v27, v119, 0, v27
    v_fma_f32 v26, v104, 0, v26
    v_fma_f32 v27, v120, 0, v27
    v_fma_f32 v26, v105, 0, v26
    v_fma_f32 v27, v121, 0, v27
    v_fma_f32 v26, v106, 0, v26
    v_fma_f32 v27, v122, 0, v27
    v_fma_f32 v26, v107, 0, v26
    v_fma_f32 v27, v123, 0, v27
    v_max3_f32 v30, v30, abs(v99), abs(v100)
    v_max3_f32 v30, v30, abs(v101), abs(v102)
    v_max_f32 v30, v30, abs(v103)
    v_max3_f32 v31, v31, abs(v115), abs(v116)
    v_max3_f32 v31, v31, abs(v117), abs(v118)
    v_max_f32 v31, v31, abs(v119)
    v_max_f32 v24, v24, v25
    v_min_f32 v30, v30, v31
    v_mov_b32 v28, 0x76800000
    v_mov_b32 v31, 0x08800000
    v_cmp_u_f32 s[44:45], v26, v27
    v_cmp_nlt_f32 vcc, v24, v28
    v_cmp_lt_f32 s[50:51], v30, v31
    s_nop 1
    s_or_b64 vcc, vcc, s[44:45]
    s_or_b64 vcc, vcc, s[50:51]
    s_cbranch_vccnz L_attn_fallback
L_attn_fin:
    s_lshl_b32 s40, s2, 2
    s_add_u32 s40, s40, s3
    s_add_u32 s40, s40, 256
    s_lshl_b32 s40, s40, 7
    v_mov_b32 v8, s18
    v_mov_b32 v9, s19
    v_mov_b32 v10, s18
    v_mov_b32 v11, s19
    s_waitcnt vmcnt(0)
    s_mov_b64 exec, 0xff
    buffer_store_dwordx4 v[8:11], v21, s[20:23], s40 offen sc1
    s_mov_b64 exec, -1
    s_barrier
    s_branch L_end
L_attn_fallback:
    s_waitcnt vmcnt(0)
    v_subrev_u32 v4, 160704, v4
    s_mov_b32 exec_lo, 0
    v_mov_b32 v12, 0
    v_mov_b32 v13, 0
    v_mov_b32 v18, 0
    v_mov_b32 v19, 0
    s_mov_b64 exec, -1
    v_mov_b32 v24, 0xff800000
    v_mov_b32 v25, 0xff800000
    s_mov_b32 s46, 0
L_fb_max:
    buffer_load_dwordx4 v[136:139], v4, s[32:35], s46 offen sc1
    s_mov_b32 exec_hi, 0
    buffer_load_dwordx2 v[140:141], v5, s[32:35], s46 offen sc1
    s_mov_b64 exec, -1
    s_waitcnt vmcnt(0)
    v_mfma_f32_32x32x16_bf16 v[64:79], v[136:139], v[8:11], 0
    v_mfma_f32_32x32x16_bf16 v[80:95], v[136:139], v[14:17], 0
    v_mfma_f32_32x32x8_bf16 v[64:79], v[140:141], v[12:13], v[64:79]
    v_mfma_f32_32x32x8_bf16 v[80:95], v[140:141], v[18:19], v[80:95]
    s_nop 15
    v_max3_f32 v24, v24, v64, v65
    v_max3_f32 v24, v24, v66, v67
    v_max3_f32 v24, v24, v68, v69
    v_max3_f32 v24, v24, v70, v71
    v_max3_f32 v24, v24, v72, v73
    v_max3_f32 v24, v24, v74, v75
    v_max3_f32 v24, v24, v76, v77
    v_max3_f32 v24, v24, v78, v79
    v_max3_f32 v25, v25, v80, v81
    v_max3_f32 v25, v25, v82, v83
    v_max3_f32 v25, v25, v84, v85
    v_max3_f32 v25, v25, v86, v87
    v_max3_f32 v25, v25, v88, v89
    v_max3_f32 v25, v25, v90, v91
    v_max3_f32 v25, v25, v92, v93
    v_max3_f32 v25, v25, v94, v95
    s_add_u32 s46, s46, 2560
    s_cmp_lt_u32 s46, 163840
    s_cbranch_scc1 L_fb_max
    v_mov_b32 v26, v24
    v_mov_b32 v27, v25
    s_nop 1
    v_permlane32_swap_b32 v24, v26
    v_permlane32_swap_b32 v25, v27
    s_nop 1
    v_max_f32 v24, v24, v26
    v_max_f32 v25, v25, v27
    s_mov_b32 s45, 0xffff0000
    s_mov_b32 s46, 0x07060302
    v_sub_f32 v24, 0, v24
    v_sub_f32 v25, 0, v25
    v_and_b32 v26, s45, v24
    v_sub_f32 v27, v24, v26
    v_and_b32 v28, s45, v27
    v_sub_f32 v27, v27, v28
    v_perm_b32 v26, v28, v26, s46
    v_lshrrev_b32 v27, 16, v27
    s_mov_b32 exec_lo, 0
    v_mov_b32 v12, v26
    v_mov_b32 v13, v27
    s_mov_b64 exec, -1
    v_and_b32 v26, s45, v25
    v_sub_f32 v27, v25, v26
    v_and_b32 v28, s45, v27
    v_sub_f32 v27, v27, v28
    v_perm_b32 v26, v28, v26, s46
    v_lshrrev_b32 v27, 16, v27
    s_mov_b32 exec_lo, 0
    v_mov_b32 v18, v26
    v_mov_b32 v19, v27
    s_mov_b64 exec, -1
    s_nop 1
    v_mov_b32 v96, 0
    v_mov_b32 v97, 0
    v_mov_b32 v98, 0
    v_mov_b32 v99, 0
    v_mov_b32 v100, 0
    v_mov_b32 v101, 0
    v_mov_b32 v102, 0
    v_mov_b32 v103, 0
    v_mov_b32 v104, 0
    v_mov_b32 v105, 0
    v_mov_b32 v106, 0
    v_mov_b32 v107, 0
    v_mov_b32 v108, 0
    v_mov_b32 v109, 0
    v_mov_b32 v110, 0
    v_mov_b32 v111, 0
    v_mov_b32 v112, 0
    v_mov_b32 v113, 0
    v_mov_b32 v114, 0
    v_mov_b32 v115, 0
    v_mov_b32 v116, 0
    v_mov_b32 v117, 0
    v_mov_b32 v118, 0
    v_mov_b32 v119, 0
    v_mov_b32 v120, 0
    v_mov_b32 v121, 0
    v_mov_b32 v122, 0
    v_mov_b32 v123, 0
    v_mov_b32 v124, 0
    v_mov_b32 v125, 0
    v_mov_b32 v126, 0
    v_mov_b32 v127, 0
    s_mov_b32 s46, 0
L_fb_main:
    buffer_load_dwordx4 v[136:139], v4, s[32:35], s46 offen sc1
    s_mov_b32 exec_hi, 0
    buffer_load_dwordx2 v[140:141], v5, s[32:35], s46 offen sc1
    s_mov_b64 exec, -1
    s_mov_b64 exec, s[48:49]
    buffer_load_dwordx4 v[148:151], v29, s[32:35], s46 offen sc1
    buffer_load_dwordx4 v[152:155], v29, s[32:35], s46 offen offset:640 sc1
    s_mov_b64 exec, -1
    s_waitcnt vmcnt(0)
    v_mfma_f32_32x32x16_bf16 v[64:79], v[136:139], v[8:11], 0
    v_mfma_f32_32x32x16_bf16 v[80:95], v[136:139], v[14:17], 0
    v_mfma_f32_32x32x8_bf16 v[64:79], v[140:141], v[12:13], v[64:79]
    v_mfma_f32_32x32x8_bf16 v[80:95], v[140:141], v[18:19], v[80:95]
    s_nop 15
    v_exp_f32 v64, v64
    v_exp_f32 v65, v65
    v_exp_f32 v66, v66
    v_exp_f32 v67, v67
    v_exp_f32 v68, v68
    v_exp_f32 v69, v69
    v_exp_f32 v70, v70
    v_exp_f32 v71, v71
    v_exp_f32 v72, v72
    v_exp_f32 v73, v73
    v_exp_f32 v74, v74
    v_exp_f32 v75, v75
    v_exp_f32 v76, v76
    v_exp_f32 v77, v77
    v_exp_f32 v78, v78
    v_exp_f32 v79, v79
    s_nop 0
    v_cvt_pk_bf16_f32 v128, v64, v65
    v_cvt_pk_bf16_f32 v129, v66, v67
    v_cvt_pk_bf16_f32 v130, v68, v69
    v_cvt_pk_bf16_f32 v131, v70, v71
    v_cvt_pk_bf16_f32 v132, v72, v73
    v_cvt_pk_bf16_f32 v133, v74, v75
    v_cvt_pk_bf16_f32 v134, v76, v77
    v_cvt_pk_bf16_f32 v135, v78, v79
    s_nop 1
    v_mfma_f32_32x32x16_bf16 v[96:111], v[148:151], v[128:131], v[96:111]
    v_mfma_f32_32x32x16_bf16 v[96:111], v[152:155], v[132:135], v[96:111]
    v_exp_f32 v80, v80
    v_exp_f32 v81, v81
    v_exp_f32 v82, v82
    v_exp_f32 v83, v83
    v_exp_f32 v84, v84
    v_exp_f32 v85, v85
    v_exp_f32 v86, v86
    v_exp_f32 v87, v87
    v_exp_f32 v88, v88
    v_exp_f32 v89, v89
    v_exp_f32 v90, v90
    v_exp_f32 v91, v91
    v_exp_f32 v92, v92
    v_exp_f32 v93, v93
    v_exp_f32 v94, v94
    v_exp_f32 v95, v95
    s_nop 0
    v_cvt_pk_bf16_f32 v128, v80, v81
    v_cvt_pk_bf16_f32 v129, v82, v83
    v_cvt_pk_bf16_f32 v130, v84, v85
    v_cvt_pk_bf16_f32 v131, v86, v87
    v_cvt_pk_bf16_f32 v132, v88, v89
    v_cvt_pk_bf16_f32 v133, v90, v91
    v_cvt_pk_bf16_f32 v134, v92, v93
    v_cvt_pk_bf16_f32 v135, v94, v95
    s_nop 1
    v_mfma_f32_32x32x16_bf16 v[112:127], v[148:151], v[128:131], v[112:127]
    v_mfma_f32_32x32x16_bf16 v[112:127], v[152:155], v[132:135], v[112:127]
    s_add_u32 s46, s46, 2560
    s_cmp_lt_u32 s46, 163840
    s_cbranch_scc1 L_fb_main
    s_nop 15
    s_branch L_attn_post
L_aux:
    s_setprio 0
    s_sub_u32 s44, s3, 4
    v_lshlrev_b32 v2, 4, v1
    s_waitcnt vmcnt(0)
    v_mov_b32 v3, 1
    s_mov_b64 exec, 1
    ds_add_u32 v23, v3 offset:8
    s_mov_b64 exec, -1
    s_cmp_eq_u32 s44, 0
    s_cbranch_scc1 L_kv
    s_cmp_lg_u32 s44, 1
    s_cbranch_scc1 L_aux_wait
    s_lshl_b32 s40, s2, 7
L_cnt_spin:
    s_sleep 1
    ds_read_b32 v3, v23 offset:8
    s_waitcnt lgkmcnt(0)
    v_readfirstlane_b32 s41, v3
    s_nop 0
    s_cmp_lt_u32 s41, 8
    s_cbranch_scc1 L_cnt_spin
    v_mov_b32 v8, s18
    v_mov_b32 v9, s19
    v_mov_b32 v10, s18
    v_mov_b32 v11, s19
    v_lshlrev_b32 v12, 4, v1
    s_mov_b64 exec, 0xff
    s_add_u32 s41, s40, 163840
    buffer_store_dwordx4 v[8:11], v12, s[20:23], s41 offen
    buffer_store_dwordx4 v[8:11], v12, s[20:23], s40 offen sc1
    s_mov_b64 exec, -1
L_aux_wait:
    s_sleep 16
    ds_read_b32 v3, v23 offset:0
    s_waitcnt lgkmcnt(0)
    v_readfirstlane_b32 s41, v3
    s_nop 0
    s_cmp_lt_u32 s41, 6
    s_cbranch_scc1 L_aux_wait
    s_branch L_kv_done
L_kv:
    s_mul_i32 s40, s26, 163840
    s_add_u32 s28, s16, s40
    s_addc_u32 s29, s17, 0
    s_mov_b32 s30, 163840
    s_mov_b32 s31, 0x00020000
    v_mul_u32_u24 v6, 5184, v1
    v_min_u32 v6, 155520, v6
    v_mov_b32 v8, 0x3f803f80
    v_mov_b32 v9, 0x3f803f80
    v_mov_b32 v10, 0x3f803f80
    v_mov_b32 v11, 0x3f803f80
    ds_write_b128 v6, v[8:11] offset:5120
    v_mov_b32 v12, 0
    v_mov_b32 v13, 0
    v_mov_b32 v14, 0
    v_mov_b32 v15, 0
    ds_write_b128 v6, v[12:15] offset:5136
    v_mov_b32 v16, 0x3f803f80
    v_mov_b32 v17, 0x3f80
    ds_write_b64 v6, v[16:17] offset:5152
    s_lshr_b32 s41, s26, 3
    s_lshl_b32 s41, s41, 1
    s_and_b32 s43, s24, 1
    s_lshl_b32 s43, s43, 3
    s_lshl_b32 s42, s27, 1
    v_and_b32 v3, 15, v1
    v_lshrrev_b32 v5, 4, v1
    v_add_u32 v5, 1, v5
    v_and_b32 v4, 7, v1
    v_add_u32 v4, s43, v4
    v_bfe_u32 v6, v1, 3, 1
    v_add_u32 v6, 1, v6
    v_cmp_gt_u32 vcc, 32, v1
    v_and_b32 v7, 1, v1
    v_add_u32 v7, s42, v7
    v_cndmask_b32 v3, v4, v3, vcc
    v_cndmask_b32 v5, v6, v5, vcc
    v_cmp_gt_u32 vcc, 48, v1
    v_add_u32 v6, -48, v1
    v_mov_b32 v4, 1280
    v_cndmask_b32 v3, v7, v3, vcc
    v_cndmask_b32 v5, 0, v5, vcc
    v_cmp_gt_u32 vcc, 2, v6
    v_cmp_gt_u32 s[46:47], 32, v1
    v_and_b32 v7, 7, v3
    v_lshl_add_u32 v5, v5, 3, v7
    s_or_b64 vcc, vcc, s[46:47]
    v_lshrrev_b32 v3, 3, v3
    v_add_u32 v3, s41, v3
    v_cndmask_b32 v4, v4, 0, vcc
    v_lshl_add_u32 v5, v5, 3, v3
    v_add_u32 v5, v5, v4
    v_lshlrev_b32 v5, 7, v5
    s_mov_b32 s40, 199999
    v_mov_b32 v6, 0
    v_mov_b32 v7, 0
L_kv_p1:
    s_sleep 1
    s_and_b32 s48, s40, 7
    s_cmp_eq_u32 s48, 0
    s_cselect_b32 exec_lo, -1, 0
    s_cselect_b32 exec_hi, -1, 0xcffff
    buffer_load_dwordx2 v[6:7], v5, s[20:23], 0 offen sc1
    s_mov_b64 exec, -1
    s_waitcnt vmcnt(0)
    v_cmp_eq_u64 vcc, s[18:19], v[6:7]
    s_sub_u32 s40, s40, 1
    s_cselect_b32 s47, 0xffff, 0
    s_and_b32 s48, vcc_hi, 0xff
    s_lshl_b32 s48, s48, s43
    s_or_b32 s48, s48, vcc_lo
    s_bfe_u32 s49, vcc_hi, 0x80008
    s_lshl_b32 s49, s49, s43
    s_lshr_b32 s45, vcc_lo, 16
    s_or_b32 s45, s45, s49
    s_and_b32 s45, s45, s48
    s_or_b32 s45, s45, s47
    s_cmp_lg_u32 s47, 0
    s_cbranch_scc1 L_kv_first
    s_lshr_b32 s48, vcc_hi, 16
    s_lshr_b32 s49, vcc_hi, 18
    s_or_b32 s48, s48, s49
    s_and_b32 s48, s48, 3
    s_cmp_eq_u32 s48, 3
    s_cselect_b32 s48, s45, 0
    s_cmp_eq_u32 s48, 0
    s_cbranch_scc1 L_kv_p1
L_kv_first:
    s_ff1_i32_b32 s48, s45
    s_add_u32 s49, s48, 1
    v_mov_b32 v4, s49
    ds_write_b32 v23, v4 offset:4
    s_lshl_b32 s46, 1, s48
    s_mul_i32 s48, s48, 10240
    s_add_u32 s48, s48, 5120
    s_mov_b32 m0, 0
    s_nop 0
    buffer_load_dwordx4 v2, s[28:31], s48 offen sc1 lds
    s_add_u32 s48, s48, 1024
    s_mov_b32 m0, 1024
    s_nop 0
    buffer_load_dwordx4 v2, s[28:31], s48 offen sc1 lds
    s_add_u32 s48, s48, 1024
    s_mov_b32 m0, 2048
    s_nop 0
    buffer_load_dwordx4 v2, s[28:31], s48 offen sc1 lds
    s_add_u32 s48, s48, 1024
    s_mov_b32 m0, 3072
    s_nop 0
    buffer_load_dwordx4 v2, s[28:31], s48 offen sc1 lds
    s_add_u32 s48, s48, 1024
    s_mov_b32 m0, 4096
    s_nop 0
    buffer_load_dwordx4 v2, s[28:31], s48 offen sc1 lds
    s_mov_b32 s50, 1
    s_mov_b32 s51, 5184
L_kv_next:
    s_andn2_b32 s48, s45, s46
    s_cbranch_scc0 L_kv_poll
    s_ff1_i32_b32 s48, s48
    s_bitset1_b32 s46, s48
    s_mul_i32 s48, s48, 10240
    s_add_u32 m0, s51, 0
    s_nop 0
    buffer_load_dwordx4 v2, s[28:31], s48 offen sc1 lds
    s_add_u32 m0, s51, 1024
    s_add_u32 s48, s48, 1024
    buffer_load_dwordx4 v2, s[28:31], s48 offen sc1 lds
    s_add_u32 m0, s51, 2048
    s_add_u32 s48, s48, 1024
    buffer_load_dwordx4 v2, s[28:31], s48 offen sc1 lds
    s_add_u32 m0, s51, 3072
    s_add_u32 s48, s48, 1024
    buffer_load_dwordx4 v2, s[28:31], s48 offen sc1 lds
    s_add_u32 m0, s51, 4096
    s_add_u32 s48, s48, 1024
    buffer_load_dwordx4 v2, s[28:31], s48 offen sc1 lds
    s_add_u32 m0, s51, 5184
    s_add_u32 s48, s48, 1024
    buffer_load_dwordx4 v2, s[28:31], s48 offen sc1 lds
    s_add_u32 m0, s51, 6208
    s_add_u32 s48, s48, 1024
    buffer_load_dwordx4 v2, s[28:31], s48 offen sc1 lds
    s_add_u32 m0, s51, 7232
    s_add_u32 s48, s48, 1024
    buffer_load_dwordx4 v2, s[28:31], s48 offen sc1 lds
    s_add_u32 m0, s51, 8256
    s_add_u32 s48, s48, 1024
    buffer_load_dwordx4 v2, s[28:31], s48 offen sc1 lds
    s_add_u32 m0, s51, 9280
    s_add_u32 s48, s48, 1024
    buffer_load_dwordx4 v2, s[28:31], s48 offen sc1 lds
    s_add_u32 s51, s51, 10368
    s_cmp_eq_u32 s50, 1
    s_cbranch_scc0 L_kv_w20
    s_waitcnt vmcnt(10)
    v_mov_b32 v4, s50
    ds_write_b32 v23, v4 offset:0
    s_mov_b32 s50, 2
    s_branch L_kv_next
L_kv_w20:
    s_waitcnt vmcnt(20)
    s_sub_u32 s49, s50, 1
    v_mov_b32 v4, s49
    ds_write_b32 v23, v4 offset:0
    s_add_u32 s50, s50, 1
    s_branch L_kv_next
L_kv_poll:
    s_waitcnt vmcnt(0)
    v_mov_b32 v4, s50
    ds_write_b32 v23, v4 offset:0
    s_cmp_eq_u32 s50, 16
    s_cbranch_scc1 L_kv_done
    buffer_load_dwordx2 v[6:7], v5, s[20:23], 0 offen sc1
    s_waitcnt vmcnt(0)
    v_cmp_eq_u64 vcc, s[18:19], v[6:7]
    s_sub_u32 s40, s40, 1
    s_cselect_b32 s47, 0xffff, 0
    s_and_b32 s48, vcc_hi, 0xff
    s_lshl_b32 s48, s48, s43
    s_or_b32 s48, s48, vcc_lo
    s_bfe_u32 s49, vcc_hi, 0x80008
    s_lshl_b32 s49, s49, s43
    s_lshr_b32 s45, vcc_lo, 16
    s_or_b32 s45, s45, s49
    s_and_b32 s45, s45, s48
    s_or_b32 s45, s45, s47
    s_branch L_kv_next
L_kv_done:
    s_branch L_all0
L_all:
    s_sleep 16
L_all0:
    ds_read_b32 v3, v23 offset:0
    s_waitcnt lgkmcnt(0)
    v_readfirstlane_b32 s41, v3
    s_nop 0
    s_cmp_lt_u32 s41, 16
    s_cbranch_scc1 L_all
    v_lshlrev_b32 v5, 7, v1
    v_add_u32 v5, 24576, v5
    s_mov_b32 s40, 200000
L_poll_22:
    buffer_load_dwordx2 v[6:7], v5, s[20:23], 0 offen sc1
    s_waitcnt vmcnt(0)
    v_cmp_ne_u64 vcc, s[18:19], v[6:7]
    s_sub_u32 s40, s40, 1
    s_cbranch_vccz L_pollok_23
    s_cmp_eq_u32 s40, 0
    s_cbranch_scc1 L_pollok_23
    s_sleep 4
    s_branch L_poll_22
L_pollok_23:
    s_setprio 3
    s_sub_u32 s40, 31, s25
    s_cmp_ge_u32 s40, 24
    s_cbranch_scc1 L_wo
    s_mul_i32 s41, s24, 24
    s_add_u32 s40, s40, s41
    s_cmp_ge_u32 s40, 187
    s_cbranch_scc1 L_wo
    s_mul_i32 s41, s40, 373
    s_lshr_b32 s41, s41, 12
    s_mul_i32 s42, s41, 11
    s_sub_u32 s42, s40, s42
    s_lshl_b32 s41, s41, 1
    s_cmp_ge_u32 s41, 18
    s_cselect_b32 s43, 17, 0
    s_sub_u32 s41, s41, s43
    s_and_b32 s43, s41, 1
    s_lshl_b32 s45, s44, 4
    s_min_u32 s46, s44, 1
    s_add_u32 s46, s46, s45
    s_mul_i32 s47, s41, 65
    s_add_u32 s47, s47, s46
    s_lshl_b32 s47, s47, 10
    s_add_u32 s47, s47, 10485760
    s_add_u32 s28, s16, s47
    s_addc_u32 s29, s17, 0
    s_mov_b32 s30, 17408
    s_mov_b32 s31, 0x00020000
    s_and_b32 s47, s44, 2
    s_add_u32 s47, s47, s43
    s_mul_i32 s48, s47, 11
    s_add_u32 s48, s48, s42
    s_mul_i32 s48, s48, 33
    s_and_b32 s45, s45, 16
    s_add_u32 s48, s48, s45
    s_lshl_b32 s48, s48, 10
    s_add_u32 s48, s48, 11617280
    s_add_u32 s32, s16, s48
    s_addc_u32 s33, s17, 0
    s_mov_b32 s34, 33792
    s_mov_b32 s35, 0x00020000
    s_mov_b32 s36, s12
    s_mov_b32 s37, s13
    s_mov_b32 s38, 5242880
    s_mov_b32 s39, 0x00020000
    s_or_b32 s47, s44, s43
    s_cmp_lg_u32 s47, 0
    s_cbranch_scc1 L_f2_nox
    s_mov_b32 s49, 16384
    buffer_load_dwordx4 v[24:27], v2, s[28:31], s49 offen sc1
    s_mov_b32 s49, 32768
    buffer_load_dwordx4 v[28:31], v2, s[32:35], s49 offen sc1
L_f2_nox:
    s_mov_b32 s49, 0
    buffer_load_dwordx4 v[64:67], v2, s[28:31], s49 offen offset:0 sc1
    buffer_load_dwordx4 v[68:71], v2, s[32:35], s49 offen offset:0 sc1
    buffer_load_dwordx4 v[72:75], v2, s[28:31], s49 offen offset:1024 sc1
    buffer_load_dwordx4 v[76:79], v2, s[32:35], s49 offen offset:1024 sc1
    buffer_load_dwordx4 v[80:83], v2, s[28:31], s49 offen offset:2048 sc1
    buffer_load_dwordx4 v[84:87], v2, s[32:35], s49 offen offset:2048 sc1
    buffer_load_dwordx4 v[88:91], v2, s[28:31], s49 offen offset:3072 sc1
    buffer_load_dwordx4 v[92:95], v2, s[32:35], s49 offen offset:3072 sc1
    s_mov_b32 s49, 4096
    buffer_load_dwordx4 v[96:99], v2, s[28:31], s49 offen offset:0 sc1
    buffer_load_dwordx4 v[100:103], v2, s[32:35], s49 offen offset:0 sc1
    buffer_load_dwordx4 v[104:107], v2, s[28:31], s49 offen offset:1024 sc1
    buffer_load_dwordx4 v[108:111], v2, s[32:35], s49 offen offset:1024 sc1
    buffer_load_dwordx4 v[112:115], v2, s[28:31], s49 offen offset:2048 sc1
    buffer_load_dwordx4 v[116:119], v2, s[32:35], s49 offen offset:2048 sc1
    buffer_load_dwordx4 v[120:123], v2, s[28:31], s49 offen offset:3072 sc1
    buffer_load_dwordx4 v[124:127], v2, s[32:35], s49 offen offset:3072 sc1
    s_mov_b32 s49, 8192
    buffer_load_dwordx4 v[128:131], v2, s[28:31], s49 offen offset:0 sc1
    buffer_load_dwordx4 v[132:135], v2, s[32:35], s49 offen offset:0 sc1
    buffer_load_dwordx4 v[136:139], v2, s[28:31], s49 offen offset:1024 sc1
    buffer_load_dwordx4 v[140:143], v2, s[32:35], s49 offen offset:1024 sc1
    buffer_load_dwordx4 v[144:147], v2, s[28:31], s49 offen offset:2048 sc1
    buffer_load_dwordx4 v[148:151], v2, s[32:35], s49 offen offset:2048 sc1
    buffer_load_dwordx4 v[152:155], v2, s[28:31], s49 offen offset:3072 sc1
    buffer_load_dwordx4 v[156:159], v2, s[32:35], s49 offen offset:3072 sc1
    s_mov_b32 s49, 12288
    buffer_load_dwordx4 v[160:163], v2, s[28:31], s49 offen offset:0 sc1
    buffer_load_dwordx4 v[164:167], v2, s[32:35], s49 offen offset:0 sc1
    buffer_load_dwordx4 v[168:171], v2, s[28:31], s49 offen offset:1024 sc1
    buffer_load_dwordx4 v[172:175], v2, s[32:35], s49 offen offset:1024 sc1
    buffer_load_dwordx4 v[176:179], v2, s[28:31], s49 offen offset:2048 sc1
    buffer_load_dwordx4 v[180:183], v2, s[32:35], s49 offen offset:2048 sc1
    buffer_load_dwordx4 v[184:187], v2, s[28:31], s49 offen offset:3072 sc1
    buffer_load_dwordx4 v[188:191], v2, s[32:35], s49 offen offset:3072 sc1
    v_and_b32 v5, 31, v1
    v_lshrrev_b32 v4, 5, v1
    s_lshr_b32 s48, s41, 1
    s_lshl_b32 s48, s48, 6
    s_add_u32 s48, s48, s43
    s_lshl_b32 s49, s44, 4
    s_add_u32 s48, s48, s49
    v_lshl_add_u32 v47, v4, 3, s48
    v_mul_u32_u24 v47, 2560, v47
    s_cmp_ge_u32 s42, 6
    s_cselect_b32 s48, 383, 0
    s_lshl_b32 s49, s42, 6
    s_sub_u32 s48, s49, s48
    v_lshl_add_u32 v5, v5, 1, s48
    v_mov_b32 v46, 1073741824
    v_lshlrev_b32 v6, 1, v5
    v_add_u32 v40, 1280, v6
    v_cmp_ge_u32 vcc, 320, v5
    v_sub_u32 v41, 2560, v6
    v_add_u32 v6, -1, v5
    v_cndmask_b32 v40, v46, v40, vcc
    v_cmp_gt_u32 vcc, 319, v6
    v_add_u32 v33, 5227520, v40
    v_sub_u32 v33, v33, v47
    v_cndmask_b32 v41, v46, v41, vcc
    v_add_u32 v32, v47, v40
    v_add_u32 v36, v47, v41
    v_add_u32 v37, 5227520, v41
    v_sub_u32 v37, v37, v47
    v_subrev_u32 v34, 2621440, v33
    v_subrev_u32 v38, 2621440, v37
    v_add_u32 v35, 2621440, v32
    v_add_u32 v39, 2621440, v36
    v_add_u32 v42, 15360, v33
    v_add_u32 v43, 15360, v37
    v_mov_b32 v3, 160704
    s_lshl_b32 s48, s44, 10
    v_add_u32 v6, s48, v2
    s_add_u32 s49, s48, 12288
    s_lshl_b32 s50, s44, 12
    s_add_u32 s51, s50, 3072
    s_cmp_eq_u32 s44, 3
    s_cmov_b32 s49, 161728
    s_cmov_b32 s51, 161728
    v_add_u32 v7, s49, v2
    v_add_u32 v44, s50, v2
    v_add_u32 v45, s51, v2
    s_lshl_b32 s49, s44, 2
    v_add_u32 v5, s49, v3
    s_setprio 1
    s_waitcnt vmcnt(30)
    v_mfma_f32_32x32x16_bf16 v[8:23], v[64:67], v[68:71], 0
    s_waitcnt vmcnt(28)
    v_mfma_f32_32x32x16_bf16 v[8:23], v[72:75], v[76:79], v[8:23]
    s_waitcnt vmcnt(26)
    v_mfma_f32_32x32x16_bf16 v[8:23], v[80:83], v[84:87], v[8:23]
    s_waitcnt vmcnt(24)
    v_mfma_f32_32x32x16_bf16 v[8:23], v[88:91], v[92:95], v[8:23]
    s_waitcnt vmcnt(22)
    v_mfma_f32_32x32x16_bf16 v[8:23], v[96:99], v[100:103], v[8:23]
    s_waitcnt vmcnt(20)
    v_mfma_f32_32x32x16_bf16 v[8:23], v[104:107], v[108:111], v[8:23]
    s_waitcnt vmcnt(18)
    v_mfma_f32_32x32x16_bf16 v[8:23], v[112:115], v[116:119], v[8:23]
    s_waitcnt vmcnt(16)
    v_mfma_f32_32x32x16_bf16 v[8:23], v[120:123], v[124:127], v[8:23]
    s_waitcnt vmcnt(14)
    v_mfma_f32_32x32x16_bf16 v[8:23], v[128:131], v[132:135], v[8:23]
    s_waitcnt vmcnt(12)
    v_mfma_f32_32x32x16_bf16 v[8:23], v[136:139], v[140:143], v[8:23]
    s_waitcnt vmcnt(10)
    v_mfma_f32_32x32x16_bf16 v[8:23], v[144:147], v[148:151], v[8:23]
    s_waitcnt vmcnt(8)
    v_mfma_f32_32x32x16_bf16 v[8:23], v[152:155], v[156:159], v[8:23]
    s_waitcnt vmcnt(6)
    v_mfma_f32_32x32x16_bf16 v[8:23], v[160:163], v[164:167], v[8:23]
    s_waitcnt vmcnt(4)
    v_mfma_f32_32x32x16_bf16 v[8:23], v[168:171], v[172:175], v[8:23]
    s_waitcnt vmcnt(2)
    v_mfma_f32_32x32x16_bf16 v[8:23], v[176:179], v[180:183], v[8:23]
    s_waitcnt vmcnt(0)
    v_mfma_f32_32x32x16_bf16 v[8:23], v[184:187], v[188:191], v[8:23]
    s_cmp_lg_u32 s47, 0
    s_cbranch_scc1 L_f2_nox2
    v_mfma_f32_32x32x16_bf16 v[8:23], v[24:27], v[28:31], v[8:23]
L_f2_nox2:
    s_setprio 3
L_f2_dead:
    ds_read_b128 v[48:51], v3 offset:16
    s_waitcnt lgkmcnt(0)
    v_min3_u32 v48, v48, v49, v50
    v_min_u32 v48, v48, v51
    s_nop 0
    v_readfirstlane_b32 s48, v48
    s_nop 0
    s_cmp_lg_u32 s48, 0
    s_cbranch_scc1 L_f2_dead_ok
    s_sleep 16
    s_branch L_f2_dead
L_f2_dead_ok:
    s_nop 3
    ds_write_b128 v6, v[8:11] offset:0
    ds_write_b128 v6, v[12:15] offset:4096
    ds_write_b128 v6, v[16:19] offset:8192
    ds_write_b128 v7, v[20:23]
    ds_write_b32 v5, v3 offset:32
L_f2_wait:
    ds_read_b128 v[48:51], v3 offset:32
    s_waitcnt lgkmcnt(0)
    v_min3_u32 v48, v48, v49, v50
    v_min_u32 v48, v48, v51
    s_nop 0
    v_readfirstlane_b32 s48, v48
    s_nop 0
    s_cmp_lg_u32 s48, 0
    s_cbranch_scc1 L_f2_wait_ok
    s_sleep 8
    s_branch L_f2_wait
L_f2_wait_ok:
    ds_read_b128 v[8:11], v44 offset:0
    ds_read_b128 v[12:15], v44 offset:1024
    ds_read_b128 v[16:19], v44 offset:2048
    ds_read_b128 v[20:23], v45
    s_waitcnt lgkmcnt(0)
    v_pk_add_f32 v[48:49], v[8:9], v[12:13]
    v_pk_add_f32 v[52:53], v[8:9], v[12:13] neg_lo:[0,1] neg_hi:[0,1]
    v_pk_add_f32 v[56:57], v[20:21], v[16:17]
    v_pk_add_f32 v[60:61], v[20:21], v[16:17] neg_lo:[0,1] neg_hi:[0,1]
    v_pk_add_f32 v[50:51], v[10:11], v[14:15]
    v_pk_add_f32 v[54:55], v[10:11], v[14:15] neg_lo:[0,1] neg_hi:[0,1]
    v_pk_add_f32 v[58:59], v[22:23], v[18:19]
    v_pk_add_f32 v[62:63], v[22:23], v[18:19] neg_lo:[0,1] neg_hi:[0,1]
    v_pk_add_f32 v[8:9], v[48:49], v[56:57] neg_lo:[0,1] neg_hi:[0,1]
    v_pk_add_f32 v[12:13], v[48:49], v[56:57]
    v_pk_add_f32 v[16:17], v[52:53], v[60:61] neg_lo:[0,1] neg_hi:[0,1]
    v_pk_add_f32 v[20:21], v[52:53], v[60:61]
    v_pk_add_f32 v[10:11], v[50:51], v[58:59] neg_lo:[0,1] neg_hi:[0,1]
    v_pk_add_f32 v[14:15], v[50:51], v[58:59]
    v_pk_add_f32 v[18:19], v[54:55], v[62:63] neg_lo:[0,1] neg_hi:[0,1]
    v_pk_add_f32 v[22:23], v[54:55], v[62:63]
    v_cvt_pk_bf16_f32 v48, v8, v9
    v_cvt_pk_bf16_f32 v49, v10, v11
    v_cvt_pk_bf16_f32 v50, v12, v13
    v_cvt_pk_bf16_f32 v51, v14, v15
    v_cvt_pk_bf16_f32 v52, v16, v17
    v_cvt_pk_bf16_f32 v53, v18, v19
    v_cvt_pk_bf16_f32 v54, v20, v21
    v_cvt_pk_bf16_f32 v55, v22, v23
    s_cmp_eq_u32 s41, 16
    s_cbranch_scc1 L_f2_nyq
    s_mov_b32 s47, 0
    s_mov_b32 s48, 15360
    buffer_store_short v48, v32, s[36:39], s47 offen sc1
    buffer_store_short v50, v36, s[36:39], s47 offen sc1
    buffer_store_short v54, v35, s[36:39], s47 offen sc1
    buffer_store_short v52, v39, s[36:39], s47 offen sc1
    buffer_store_short v52, v34, s[36:39], s48 offen sc1
    buffer_store_short v54, v38, s[36:39], s48 offen sc1
    buffer_store_short v50, v42, s[36:39], 0 offen sc1
    buffer_store_short v48, v43, s[36:39], 0 offen sc1
    s_mov_b32 s47, 5120
    s_mov_b32 s48, 10240
    buffer_store_short_d16_hi v48, v32, s[36:39], s47 offen sc1
    buffer_store_short_d16_hi v50, v36, s[36:39], s47 offen sc1
    buffer_store_short_d16_hi v54, v35, s[36:39], s47 offen sc1
    buffer_store_short_d16_hi v52, v39, s[36:39], s47 offen sc1
    buffer_store_short_d16_hi v52, v34, s[36:39], s48 offen sc1
    buffer_store_short_d16_hi v54, v38, s[36:39], s48 offen sc1
    buffer_store_short_d16_hi v50, v33, s[36:39], s48 offen sc1
    buffer_store_short_d16_hi v48, v37, s[36:39], s48 offen sc1
    s_mov_b32 s47, 10240
    s_mov_b32 s48, 5120
    buffer_store_short v49, v32, s[36:39], s47 offen sc1
    buffer_store_short v51, v36, s[36:39], s47 offen sc1
    buffer_store_short v55, v35, s[36:39], s47 offen sc1
    buffer_store_short v53, v39, s[36:39], s47 offen sc1
    buffer_store_short v53, v34, s[36:39], s48 offen sc1
    buffer_store_short v55, v38, s[36:39], s48 offen sc1
    buffer_store_short v51, v33, s[36:39], s48 offen sc1
    buffer_store_short v49, v37, s[36:39], s48 offen sc1
    s_mov_b32 s47, 15360
    s_mov_b32 s48, 0
    buffer_store_short_d16_hi v49, v32, s[36:39], s47 offen sc1
    buffer_store_short_d16_hi v51, v36, s[36:39], s47 offen sc1
    buffer_store_short_d16_hi v55, v35, s[36:39], s47 offen sc1
    buffer_store_short_d16_hi v53, v39, s[36:39], s47 offen sc1
    buffer_store_short_d16_hi v53, v34, s[36:39], s48 offen sc1
    buffer_store_short_d16_hi v55, v38, s[36:39], s48 offen sc1
    buffer_store_short_d16_hi v51, v33, s[36:39], s48 offen sc1
    buffer_store_short_d16_hi v49, v37, s[36:39], s48 offen sc1
    s_branch L_wo
L_f2_nyq:
    s_cmp_lg_u32 s44, 0
    s_cbranch_scc1 L_wo
    s_mov_b32 exec_hi, 0
    buffer_store_short v48, v32, s[36:39], 0 offen sc1
    buffer_store_short v50, v36, s[36:39], 0 offen sc1
    buffer_store_short v50, v42, s[36:39], 0 offen sc1
    buffer_store_short v48, v43, s[36:39], 0 offen sc1
    s_mov_b64 exec, -1
L_wo:
    s_setprio 3
    s_and_b32 s40, s26, 3
    s_lshl_b32 s40, s40, 2
    s_add_u32 s40, s40, s44
    s_mul_i32 s40, s40, 51200
    s_add_u32 s40, s40, 13104128
    s_add_u32 s28, s16, s40
    s_addc_u32 s29, s17, 0
    s_mov_b32 s30, 51200
    s_mov_b32 s31, 0x00020000
    s_waitcnt vmcnt(0)
    s_mov_b32 s49, 0
    buffer_load_dwordx4 v[56:59], v2, s[28:31], s49 offen offset:0 sc1
    buffer_load_dwordx4 v[60:63], v2, s[28:31], s49 offen offset:1024 sc1
    buffer_load_dwordx4 v[64:67], v2, s[28:31], s49 offen offset:2048 sc1
    buffer_load_dwordx4 v[68:71], v2, s[28:31], s49 offen offset:3072 sc1
    s_mov_b32 s49, 4096
    buffer_load_dwordx4 v[72:75], v2, s[28:31], s49 offen offset:0 sc1
    buffer_load_dwordx4 v[76:79], v2, s[28:31], s49 offen offset:1024 sc1
    buffer_load_dwordx4 v[80:83], v2, s[28:31], s49 offen offset:2048 sc1
    buffer_load_dwordx4 v[84:87], v2, s[28:31], s49 offen offset:3072 sc1
    s_mov_b32 s49, 8192
    buffer_load_dwordx4 v[88:91], v2, s[28:31], s49 offen offset:0 sc1
    buffer_load_dwordx4 v[92:95], v2, s[28:31], s49 offen offset:1024 sc1
    buffer_load_dwordx4 v[96:99], v2, s[28:31], s49 offen offset:2048 sc1
    buffer_load_dwordx4 v[100:103], v2, s[28:31], s49 offen offset:3072 sc1
    s_mov_b32 s49, 12288
    buffer_load_dwordx4 v[104:107], v2, s[28:31], s49 offen offset:0 sc1
    buffer_load_dwordx4 v[108:111], v2, s[28:31], s49 offen offset:1024 sc1
    buffer_load_dwordx4 v[112:115], v2, s[28:31], s49 offen offset:2048 sc1
    buffer_load_dwordx4 v[116:119], v2, s[28:31], s49 offen offset:3072 sc1
    s_mov_b32 s49, 16384
    buffer_load_dwordx4 v[120:123], v2, s[28:31], s49 offen offset:0 sc1
    buffer_load_dwordx4 v[124:127], v2, s[28:31], s49 offen offset:1024 sc1
    buffer_load_dwordx4 v[128:131], v2, s[28:31], s49 offen offset:2048 sc1
    buffer_load_dwordx4 v[132:135], v2, s[28:31], s49 offen offset:3072 sc1
    s_mov_b32 s49, 20480
    buffer_load_dwordx4 v[136:139], v2, s[28:31], s49 offen offset:0 sc1
    buffer_load_dwordx4 v[140:143], v2, s[28:31], s49 offen offset:1024 sc1
    buffer_load_dwordx4 v[144:147], v2, s[28:31], s49 offen offset:2048 sc1
    buffer_load_dwordx4 v[148:151], v2, s[28:31], s49 offen offset:3072 sc1
    s_mov_b32 s49, 24576
    buffer_load_dwordx4 v[152:155], v2, s[28:31], s49 offen offset:0 sc1
    buffer_load_dwordx4 v[156:159], v2, s[28:31], s49 offen offset:1024 sc1
    buffer_load_dwordx4 v[160:163], v2, s[28:31], s49 offen offset:2048 sc1
    buffer_load_dwordx4 v[164:167], v2, s[28:31], s49 offen offset:3072 sc1
    s_mov_b32 s49, 28672
    buffer_load_dwordx4 v[168:171], v2, s[28:31], s49 offen offset:0 sc1
    buffer_load_dwordx4 v[172:175], v2, s[28:31], s49 offen offset:1024 sc1
    buffer_load_dwordx4 v[176:179], v2, s[28:31], s49 offen offset:2048 sc1
    buffer_load_dwordx4 v[180:183], v2, s[28:31], s49 offen offset:3072 sc1
    s_mov_b32 s49, 32768
    buffer_load_dwordx4 v[184:187], v2, s[28:31], s49 offen offset:0 sc1
    buffer_load_dwordx4 v[188:191], v2, s[28:31], s49 offen offset:1024 sc1
    buffer_load_dwordx4 v[192:195], v2, s[28:31], s49 offen offset:2048 sc1
    buffer_load_dwordx4 v[196:199], v2, s[28:31], s49 offen offset:3072 sc1
    s_mov_b32 s49, 36864
    buffer_load_dwordx4 v[200:203], v2, s[28:31], s49 offen offset:0 sc1
    buffer_load_dwordx4 v[204:207], v2, s[28:31], s49 offen offset:1024 sc1
    buffer_load_dwordx4 v[208:211], v2, s[28:31], s49 offen offset:2048 sc1
    buffer_load_dwordx4 v[212:215], v2, s[28:31], s49 offen offset:3072 sc1
    s_mov_b32 s49, 40960
    buffer_load_dwordx4 v[216:219], v2, s[28:31], s49 offen offset:0 sc1
    buffer_load_dwordx4 v[220:223], v2, s[28:31], s49 offen offset:1024 sc1
    buffer_load_dwordx4 v[224:227], v2, s[28:31], s49 offen offset:2048 sc1
    buffer_load_dwordx4 v[228:231], v2, s[28:31], s49 offen offset:3072 sc1
    s_mov_b32 s49, 45056
    buffer_load_dwordx4 v[232:235], v2, s[28:31], s49 offen offset:0 sc1
    buffer_load_dwordx4 v[236:239], v2, s[28:31], s49 offen offset:1024 sc1
    buffer_load_dwordx4 v[240:243], v2, s[28:31], s49 offen offset:2048 sc1
    buffer_load_dwordx4 v[244:247], v2, s[28:31], s49 offen offset:3072 sc1
    s_mov_b32 s49, 49152
    buffer_load_dwordx4 v[248:251], v2, s[28:31], s49 offen offset:0 sc1
    buffer_load_dwordx4 v[252:255], v2, s[28:31], s49 offen offset:1024 sc1
L_B_done:
    s_lshr_b32 s40, s26, 2
    s_lshl_b32 s41, s27, 3
    s_add_u32 s41, s41, s40
    s_mul_i32 s42, s41, 40960
    s_add_u32 s42, s42, 7864320
    s_add_u32 s28, s16, s42
    s_addc_u32 s29, s17, 0
    s_mov_b32 s30, 40960
    s_mov_b32 s31, 0x00020000
    v_and_b32 v4, 7, v1
    v_bfe_u32 v5, v1, 3, 2
    v_lshlrev_b32 v5, 1, v5
    v_lshl_add_u32 v4, v4, 3, v5
    s_and_b32 s42, s27, 3
    s_lshl_b32 s42, s42, 6
    s_lshr_b32 s43, s27, 2
    s_add_u32 s42, s42, s43
    s_lshl_b32 s42, s42, 2
    s_lshr_b32 s40, s40, 1
    s_add_u32 s42, s42, s40
    s_add_u32 s42, s42, 256
    v_lshl_add_u32 v4, v4, 2, s42
    v_lshlrev_b32 v4, 7, v4
    v_mov_b32 v8, v4
    buffer_load_dwordx2 v[10:11], v8, s[20:23], 0 offen sc1
    v_and_b32 v3, 31, v1
    v_lshrrev_b32 v4, 5, v1
    v_mul_u32_u24 v5, 2560, v4
    v_lshl_add_u32 v5, v3, 3, v5
    v_add_u32 v5, 1024, v5
    s_mov_b32 s32, s12
    s_mov_b32 s33, s13
    s_mov_b32 s34, 5242880
    s_mov_b32 s35, 0x00020000
    s_lshl_b32 s41, s41, 5
    v_add_u32 v6, s41, v3
    v_mul_u32_u24 v6, 2560, v6
    s_and_b32 s42, s26, 3
    s_mul_i32 s42, s42, 320
    s_mul_i32 s43, s44, 12800
    v_add_u32 v7, s43, v2
    s_lshl_b32 s43, s44, 12
    s_add_u32 s43, s43, 40960
    v_add_u32 v3, s43, v2
    s_lshl_b32 s43, s44, 10
    s_add_u32 s43, s43, 40960
    v_add_u32 v1, s43, v2
    s_lshl_b32 s45, s44, 4
    s_add_u32 s45, s45, s42
    v_lshl_add_u32 v0, v4, 3, v6
    s_lshl_b32 s43, s44, 6
    s_add_u32 s43, s43, s42
    v_lshl_add_u32 v6, v4, 4, v6
    s_mov_b64 vcc, -1
    s_nop 0
    s_branch L_pad_a_0
L_pad_ret:
    s_setprio 3
    s_waitcnt vmcnt(0)
    s_barrier
    s_cmp_lg_u32 s44, 0
    s_cbranch_scc1 L_onep
    s_mov_b32 s40, 200000
L_poll_24:
    buffer_load_dwordx2 v[10:11], v8, s[20:23], 0 offen sc1
    s_waitcnt vmcnt(0)
    v_cmp_ne_u64 vcc, s[18:19], v[10:11]
    s_sub_u32 s40, s40, 1
    s_cbranch_vccz L_pollok_25
    s_cmp_eq_u32 s40, 0
    s_cbranch_scc1 L_pollok_25
    s_mov_b64 exec, vcc
    s_branch L_poll_24
L_pollok_25:
    s_mov_b64 exec, -1
L_onep:
    s_barrier
    s_mov_b64 vcc, 0
    s_lshl_b32 s40, s44, 10
L_pad_a_0:
    s_cbranch_vccnz L_pad_a_1
    s_mov_b32 m0, s40
    s_nop 0
    buffer_load_dwordx4 v2, s[28:31], s40 offen sc1 lds
    s_add_u32 s40, s40, 4096
    s_mov_b32 m0, s40
    s_nop 0
    buffer_load_dwordx4 v2, s[28:31], s40 offen sc1 lds
    s_add_u32 s40, s40, 4096
    s_mov_b32 m0, s40
    s_nop 0
    buffer_load_dwordx4 v2, s[28:31], s40 offen sc1 lds
    s_add_u32 s40, s40, 4096
L_pad_a_1:
    s_cbranch_vccnz L_pad_a_2
    s_mov_b32 m0, s40
    s_nop 0
    buffer_load_dwordx4 v2, s[28:31], s40 offen sc1 lds
    s_add_u32 s40, s40, 4096
    s_mov_b32 m0, s40
    s_nop 0
    buffer_load_dwordx4 v2, s[28:31], s40 offen sc1 lds
    s_add_u32 s40, s40, 4096
    s_mov_b32 m0, s40
    s_nop 0
    buffer_load_dwordx4 v2, s[28:31], s40 offen sc1 lds
    s_add_u32 s40, s40, 4096
L_pad_a_2:
    s_cbranch_vccnz L_pad_a_3
    s_mov_b32 m0, s40
    s_nop 0
    buffer_load_dwordx4 v2, s[28:31], s40 offen sc1 lds
    s_add_u32 s40, s40, 4096
    s_mov_b32 m0, s40
    s_nop 0
    buffer_load_dwordx4 v2, s[28:31], s40 offen sc1 lds
    s_add_u32 s40, s40, 4096
    s_mov_b32 m0, s40
    s_nop 0
    buffer_load_dwordx4 v2, s[28:31], s40 offen sc1 lds
    s_add_u32 s40, s40, 4096
L_pad_a_3:
    s_cbranch_vccnz L_pad_a_4
    s_mov_b32 m0, s40
    s_nop 0
    buffer_load_dwordx4 v2, s[28:31], s40 offen sc1 lds
    s_waitcnt vmcnt(6)
    s_barrier
L_pad_a_4:
    s_cmp_eq_u32 s44, 3
    s_cbranch_vccz L_nopad
    s_cbranch_scc1 L_pad_c_0
    s_branch L_pad_b_0
L_nopad:
    s_cmp_eq_u32 s44, 3
    s_cbranch_scc1 L_tail3
    ds_read_b128 v[40:43], v2 offset:0
    ds_read_b128 v[44:47], v2 offset:1280
    ds_read_b128 v[48:51], v2 offset:2560
    s_waitcnt lgkmcnt(2)
    v_mfma_f32_32x32x16_bf16 v[24:39], v[96:99], v[40:43], 0
L_pad_b_0:
    s_cbranch_vccnz L_pad_b_1
    ds_read_b128 v[52:55], v2 offset:3840
    s_waitcnt lgkmcnt(2)
    v_mfma_f32_32x32x16_bf16 v[24:39], v[100:103], v[44:47], v[24:39]
    ds_read_b128 v[40:43], v2 offset:5120
    s_waitcnt lgkmcnt(2)
    v_mfma_f32_32x32x16_bf16 v[24:39], v[104:107], v[48:51], v[24:39]
L_pad_b_1:
    s_cbranch_vccnz L_pad_b_2
    ds_read_b128 v[44:47], v2 offset:6400
    s_waitcnt lgkmcnt(2)
    v_mfma_f32_32x32x16_bf16 v[24:39], v[108:111], v[52:55], v[24:39]
    ds_read_b128 v[48:51], v2 offset:7680
    s_waitcnt lgkmcnt(2)
    v_mfma_f32_32x32x16_bf16 v[24:39], v[112:115], v[40:43], v[24:39]
L_pad_b_2:
    s_cbranch_vccnz L_pad_b_3
    ds_read_b128 v[52:55], v2 offset:8960
    s_waitcnt lgkmcnt(2)
    v_mfma_f32_32x32x16_bf16 v[24:39], v[116:119], v[44:47], v[24:39]
    ds_read_b128 v[40:43], v2 offset:10240
    s_waitcnt lgkmcnt(2)
    v_mfma_f32_32x32x16_bf16 v[24:39], v[120:123], v[48:51], v[24:39]
L_pad_b_3:
    s_cbranch_vccnz L_pad_b_4
    ds_read_b128 v[44:47], v2 offset:11520
    s_waitcnt lgkmcnt(2)
    v_mfma_f32_32x32x16_bf16 v[24:39], v[124:127], v[52:55], v[24:39]
    s_waitcnt vmcnt(0)
    s_barrier
    ds_read_b128 v[48:51], v7 offset:0
    s_waitcnt lgkmcnt(2)
    v_mfma_f32_32x32x16_bf16 v[24:39], v[128:131], v[40:43], v[24:39]
L_pad_b_4:
    s_cbranch_vccnz L_pad_b_5
    ds_read_b128 v[52:55], v7 offset:1280
    s_waitcnt lgkmcnt(2)
    v_mfma_f32_32x32x16_bf16 v[24:39], v[132:135], v[44:47], v[24:39]
    ds_read_b128 v[40:43], v7 offset:2560
    s_waitcnt lgkmcnt(2)
    v_mfma_f32_32x32x16_bf16 v[8:23], v[56:59], v[48:51], 0
L_pad_b_5:
    s_cbranch_vccnz L_pad_b_6
    ds_read_b128 v[44:47], v7 offset:3840
    s_waitcnt lgkmcnt(2)
    v_mfma_f32_32x32x16_bf16 v[8:23], v[60:63], v[52:55], v[8:23]
    ds_read_b128 v[48:51], v7 offset:5120
    s_waitcnt lgkmcnt(2)
    v_mfma_f32_32x32x16_bf16 v[8:23], v[64:67], v[40:43], v[8:23]
L_pad_b_6:
    s_cbranch_vccnz L_pad_b_7
    ds_read_b128 v[52:55], v7 offset:6400
    s_waitcnt lgkmcnt(2)
    v_mfma_f32_32x32x16_bf16 v[8:23], v[68:71], v[44:47], v[8:23]
    ds_read_b128 v[40:43], v7 offset:7680
    s_waitcnt lgkmcnt(2)
    v_mfma_f32_32x32x16_bf16 v[8:23], v[72:75], v[48:51], v[8:23]
L_pad_b_7:
    s_cbranch_vccnz L_pad_b_8
    ds_read_b128 v[44:47], v7 offset:8960
    s_waitcnt lgkmcnt(2)
    v_mfma_f32_32x32x16_bf16 v[8:23], v[76:79], v[52:55], v[8:23]
    ds_read_b128 v[48:51], v7 offset:10240
    s_waitcnt lgkmcnt(2)
    v_mfma_f32_32x32x16_bf16 v[8:23], v[80:83], v[40:43], v[8:23]
L_pad_b_8:
    s_cbranch_vccnz L_pad_b_9
    ds_read_b128 v[52:55], v7 offset:11520
    s_waitcnt lgkmcnt(2)
    v_mfma_f32_32x32x16_bf16 v[8:23], v[84:87], v[44:47], v[8:23]
    ds_read_b128 v[40:43], v2 offset:12800
    s_waitcnt lgkmcnt(2)
    v_mfma_f32_32x32x16_bf16 v[8:23], v[88:91], v[48:51], v[8:23]
L_pad_b_9:
    s_cbranch_vccnz L_pad_b_10
    ds_read_b128 v[44:47], v2 offset:14080
    s_waitcnt lgkmcnt(2)
    v_mfma_f32_32x32x16_bf16 v[8:23], v[92:95], v[52:55], v[8:23]
    ds_read_b128 v[48:51], v2 offset:15360
    s_waitcnt lgkmcnt(2)
    v_mfma_f32_32x32x16_bf16 v[24:39], v[136:139], v[40:43], v[24:39]
L_pad_b_10:
    s_cbranch_vccnz L_pad_b_11
    ds_read_b128 v[52:55], v2 offset:16640
    s_waitcnt lgkmcnt(2)
    v_mfma_f32_32x32x16_bf16 v[24:39], v[140:143], v[44:47], v[24:39]
    ds_read_b128 v[40:43], v2 offset:17920
    s_waitcnt lgkmcnt(2)
    v_mfma_f32_32x32x16_bf16 v[24:39], v[144:147], v[48:51], v[24:39]
L_pad_b_11:
    s_cbranch_vccnz L_pad_b_12
    ds_read_b128 v[44:47], v2 offset:19200
    s_waitcnt lgkmcnt(2)
    v_mfma_f32_32x32x16_bf16 v[24:39], v[148:151], v[52:55], v[24:39]
L_pad_b_12:
    s_cbranch_vccnz L_pad_b_13
    ds_read_b128 v[48:51], v2 offset:20480
    ds_write_b128 v3, v[8:11] offset:0
    ds_write_b128 v3, v[12:15] offset:1024
    ds_write_b128 v3, v[16:19] offset:2048
    ds_write_b128 v3, v[20:23] offset:3072
    s_waitcnt lgkmcnt(6)
    v_mfma_f32_32x32x16_bf16 v[24:39], v[152:155], v[40:43], v[24:39]
L_pad_b_13:
    s_cbranch_vccnz L_pad_b_14
    ds_read_b128 v[52:55], v2 offset:21760
    s_waitcnt lgkmcnt(6)
    v_mfma_f32_32x32x16_bf16 v[24:39], v[156:159], v[44:47], v[24:39]
    ds_read_b128 v[40:43], v2 offset:23040
    s_waitcnt lgkmcnt(2)
    v_mfma_f32_32x32x16_bf16 v[24:39], v[160:163], v[48:51], v[24:39]
L_pad_b_14:
    s_cbranch_vccnz L_pad_b_15
    ds_read_b128 v[44:47], v2 offset:24320
    s_waitcnt lgkmcnt(2)
    v_mfma_f32_32x32x16_bf16 v[24:39], v[164:167], v[52:55], v[24:39]
    ds_read_b128 v[48:51], v2 offset:25600
    s_waitcnt lgkmcnt(2)
    v_mfma_f32_32x32x16_bf16 v[24:39], v[168:171], v[40:43], v[24:39]
L_pad_b_15:
    s_cbranch_vccnz L_pad_b_16
    ds_read_b128 v[52:55], v2 offset:26880
    s_waitcnt lgkmcnt(2)
    v_mfma_f32_32x32x16_bf16 v[24:39], v[172:175], v[44:47], v[24:39]
    ds_read_b128 v[40:43], v2 offset:28160
    s_waitcnt lgkmcnt(2)
    v_mfma_f32_32x32x16_bf16 v[24:39], v[176:179], v[48:51], v[24:39]
L_pad_b_16:
    s_cbranch_vccnz L_pad_b_17
    ds_read_b128 v[44:47], v2 offset:29440
    s_waitcnt lgkmcnt(2)
    v_mfma_f32_32x32x16_bf16 v[24:39], v[180:183], v[52:55], v[24:39]
    ds_read_b128 v[48:51], v2 offset:30720
    s_waitcnt lgkmcnt(2)
    v_mfma_f32_32x32x16_bf16 v[24:39], v[184:187], v[40:43], v[24:39]
L_pad_b_17:
    s_cbranch_vccnz L_pad_b_18
    ds_read_b128 v[52:55], v2 offset:32000
    s_barrier
    ds_read_b128 v[8:11], v1 offset:0
    ds_read_b128 v[12:15], v1 offset:4096
    ds_read_b128 v[16:19], v1 offset:8192
    ds_read_b128 v[20:23], v1 offset:12288
    s_waitcnt lgkmcnt(6)
    v_mfma_f32_32x32x16_bf16 v[24:39], v[188:191], v[44:47], v[24:39]
    ds_read_b128 v[40:43], v2 offset:33280
    s_waitcnt lgkmcnt(6)
    v_mfma_f32_32x32x16_bf16 v[24:39], v[192:195], v[48:51], v[24:39]
L_pad_b_18:
    s_cbranch_vccnz L_pad_b_19
    ds_read_b128 v[44:47], v2 offset:34560
    s_waitcnt lgkmcnt(2)
    v_mfma_f32_32x32x16_bf16 v[24:39], v[196:199], v[52:55], v[24:39]
    ds_read_b128 v[48:51], v2 offset:35840
    s_waitcnt lgkmcnt(2)
    v_mfma_f32_32x32x16_bf16 v[24:39], v[200:203], v[40:43], v[24:39]
L_pad_b_19:
    s_cbranch_vccnz L_pad_b_20
    ds_read_b128 v[52:55], v2 offset:37120
    s_waitcnt lgkmcnt(2)
    v_mfma_f32_32x32x16_bf16 v[24:39], v[204:207], v[44:47], v[24:39]
    ds_read_b128 v[40:43], v2 offset:38400
    s_waitcnt lgkmcnt(2)
    v_mfma_f32_32x32x16_bf16 v[24:39], v[208:211], v[48:51], v[24:39]
L_pad_b_20:
    s_cbranch_vccnz L_pad_b_21
    ds_read_b128 v[44:47], v2 offset:39680
    v_pk_add_f32 v[8:9], v[8:9], v[12:13]
    v_pk_add_f32 v[10:11], v[10:11], v[14:15]
    v_pk_add_f32 v[8:9], v[8:9], v[16:17]
    v_pk_add_f32 v[10:11], v[10:11], v[18:19]
    v_pk_add_f32 v[8:9], v[8:9], v[20:21]
    v_pk_add_f32 v[10:11], v[10:11], v[22:23]
    s_waitcnt lgkmcnt(2)
    v_mfma_f32_32x32x16_bf16 v[24:39], v[212:215], v[52:55], v[24:39]
    ds_read_b64 v[48:49], v5 offset:0
    ds_read_b64 v[50:51], v5 offset:1280
    s_waitcnt lgkmcnt(3)
    v_mfma_f32_32x32x16_bf16 v[24:39], v[216:219], v[40:43], v[24:39]
L_pad_b_21:
    s_cbranch_vccnz L_pad_b_22
    ds_read_b64 v[52:53], v5 offset:5120
    ds_read_b64 v[54:55], v5 offset:6400
    v_cvt_pk_bf16_f32 v8, v8, v9
    v_cvt_pk_bf16_f32 v9, v10, v11
    buffer_store_dwordx2 v[8:9], v0, s[32:35], s45 offen offset:256
    s_waitcnt lgkmcnt(4)
    v_mfma_f32_32x32x16_bf16 v[24:39], v[220:223], v[44:47], v[24:39]
    ds_read_b64 v[40:41], v5 offset:10240
    ds_read_b64 v[42:43], v5 offset:11520
    s_waitcnt lgkmcnt(4)
    v_mfma_f32_32x32x16_bf16 v[24:39], v[224:227], v[48:51], v[24:39]
L_pad_b_22:
    s_cbranch_vccnz L_pad_b_23
    ds_read_b64 v[44:45], v5 offset:15360
    ds_read_b64 v[46:47], v5 offset:16640
    s_waitcnt lgkmcnt(4)
    v_mfma_f32_32x32x16_bf16 v[24:39], v[228:231], v[52:55], v[24:39]
    ds_read_b64 v[48:49], v5 offset:20480
    ds_read_b64 v[50:51], v5 offset:21760
    s_waitcnt lgkmcnt(4)
    v_mfma_f32_32x32x16_bf16 v[24:39], v[232:235], v[40:43], v[24:39]
L_pad_b_23:
    s_cbranch_vccnz L_pad_b_24
    ds_read_b64 v[52:53], v5 offset:25600
    ds_read_b64 v[54:55], v5 offset:26880
    s_waitcnt lgkmcnt(4)
    v_mfma_f32_32x32x16_bf16 v[24:39], v[236:239], v[44:47], v[24:39]
    ds_read_b64 v[40:41], v5 offset:30720
    ds_read_b64 v[42:43], v5 offset:32000
    s_waitcnt lgkmcnt(4)
    v_mfma_f32_32x32x16_bf16 v[24:39], v[240:243], v[48:51], v[24:39]
L_pad_b_24:
    s_cbranch_vccnz L_pad_b_25
    ds_read_b64 v[44:45], v5 offset:35840
    ds_read_b64 v[46:47], v5 offset:37120
    s_waitcnt lgkmcnt(4)
    v_mfma_f32_32x32x16_bf16 v[24:39], v[244:247], v[52:55], v[24:39]
    s_waitcnt lgkmcnt(2)
    v_mfma_f32_32x32x16_bf16 v[24:39], v[248:251], v[40:43], v[24:39]
L_pad_b_25:
    s_cbranch_vccnz L_pad_z_0
    s_waitcnt lgkmcnt(0)
    v_mfma_f32_32x32x16_bf16 v[24:39], v[252:255], v[44:47], v[24:39]
    s_branch L_tail_join
L_tail3:
    ds_read_b128 v[40:43], v2 offset:0
    ds_read_b128 v[44:47], v2 offset:1280
    ds_read_b128 v[48:51], v2 offset:2560
    s_waitcnt lgkmcnt(2)
    v_mfma_f32_32x32x16_bf16 v[24:39], v[96:99], v[40:43], 0
L_pad_c_0:
    s_cbranch_vccnz L_pad_c_1
    ds_read_b128 v[52:55], v2 offset:3840
    s_waitcnt lgkmcnt(2)
    v_mfma_f32_32x32x16_bf16 v[24:39], v[100:103], v[44:47], v[24:39]
    ds_read_b128 v[40:43], v2 offset:5120
    s_waitcnt lgkmcnt(2)
    v_mfma_f32_32x32x16_bf16 v[24:39], v[104:107], v[48:51], v[24:39]
L_pad_c_1:
    s_cbranch_vccnz L_pad_c_2
    ds_read_b128 v[44:47], v2 offset:6400
    s_waitcnt lgkmcnt(2)
    v_mfma_f32_32x32x16_bf16 v[24:39], v[108:111], v[52:55], v[24:39]
    ds_read_b128 v[48:51], v2 offset:7680
    s_waitcnt lgkmcnt(2)
    v_mfma_f32_32x32x16_bf16 v[24:39], v[112:115], v[40:43], v[24:39]
L_pad_c_2:
    s_cbranch_vccnz L_pad_c_3
    ds_read_b128 v[52:55], v2 offset:8960
    s_waitcnt lgkmcnt(2)
    v_mfma_f32_32x32x16_bf16 v[24:39], v[116:119], v[44:47], v[24:39]
    ds_read_b128 v[40:43], v2 offset:10240
    s_waitcnt lgkmcnt(2)
    v_mfma_f32_32x32x16_bf16 v[24:39], v[120:123], v[48:51], v[24:39]
L_pad_c_3:
    s_cbranch_vccnz L_pad_c_4
    ds_read_b128 v[44:47], v2 offset:11520
    s_waitcnt lgkmcnt(2)
    v_mfma_f32_32x32x16_bf16 v[24:39], v[124:127], v[52:55], v[24:39]
    s_waitcnt vmcnt(0)
    s_barrier
    ds_read_b128 v[48:51], v2 offset:38400
    s_waitcnt lgkmcnt(2)
    v_mfma_f32_32x32x16_bf16 v[24:39], v[128:131], v[40:43], v[24:39]
L_pad_c_4:
    s_cbranch_vccnz L_pad_c_5
    ds_read_b128 v[52:55], v2 offset:39680
    s_waitcnt lgkmcnt(2)
    v_mfma_f32_32x32x16_bf16 v[24:39], v[132:135], v[44:47], v[24:39]
    ds_read_b64 v[40:41], v5 offset:0
    ds_read_b64 v[42:43], v5 offset:1280
    s_waitcnt lgkmcnt(3)
    v_mfma_f32_32x32x16_bf16 v[8:23], v[56:59], v[48:51], 0
L_pad_c_5:
    s_cbranch_vccnz L_pad_c_6
    ds_read_b64 v[44:45], v5 offset:5120
    ds_read_b64 v[46:47], v5 offset:6400
    s_waitcnt lgkmcnt(4)
    v_mfma_f32_32x32x16_bf16 v[8:23], v[60:63], v[52:55], v[8:23]
    ds_read_b64 v[48:49], v5 offset:10240
    ds_read_b64 v[50:51], v5 offset:11520
    s_waitcnt lgkmcnt(4)
    v_mfma_f32_32x32x16_bf16 v[8:23], v[64:67], v[40:43], v[8:23]
L_pad_c_6:
    s_cbranch_vccnz L_pad_c_7
    ds_read_b64 v[52:53], v5 offset:15360
    ds_read_b64 v[54:55], v5 offset:16640
    s_waitcnt lgkmcnt(4)
    v_mfma_f32_32x32x16_bf16 v[8:23], v[68:71], v[44:47], v[8:23]
    ds_read_b64 v[40:41], v5 offset:20480
    ds_read_b64 v[42:43], v5 offset:21760
    s_waitcnt lgkmcnt(4)
    v_mfma_f32_32x32x16_bf16 v[8:23], v[72:75], v[48:51], v[8:23]
L_pad_c_7:
    s_cbranch_vccnz L_pad_c_8
    ds_read_b64 v[44:45], v5 offset:25600
    ds_read_b64 v[46:47], v5 offset:26880
    s_waitcnt lgkmcnt(4)
    v_mfma_f32_32x32x16_bf16 v[8:23], v[76:79], v[52:55], v[8:23]
    ds_read_b64 v[48:49], v5 offset:30720
    ds_read_b64 v[50:51], v5 offset:32000
    s_waitcnt lgkmcnt(4)
    v_mfma_f32_32x32x16_bf16 v[8:23], v[80:83], v[40:43], v[8:23]
L_pad_c_8:
    s_cbranch_vccnz L_pad_c_9
    ds_read_b64 v[52:53], v5 offset:35840
    ds_read_b64 v[54:55], v5 offset:37120
    s_waitcnt lgkmcnt(4)
    v_mfma_f32_32x32x16_bf16 v[8:23], v[84:87], v[44:47], v[8:23]
    ds_read_b128 v[40:43], v2 offset:12800
    s_waitcnt lgkmcnt(3)
    v_mfma_f32_32x32x16_bf16 v[8:23], v[88:91], v[48:51], v[8:23]
L_pad_c_9:
    s_cbranch_vccnz L_pad_c_10
    ds_read_b128 v[44:47], v2 offset:14080
    s_waitcnt lgkmcnt(2)
    v_mfma_f32_32x32x16_bf16 v[8:23], v[92:95], v[52:55], v[8:23]
    ds_read_b128 v[48:51], v2 offset:15360
    s_waitcnt lgkmcnt(2)
    v_mfma_f32_32x32x16_bf16 v[24:39], v[136:139], v[40:43], v[24:39]
L_pad_c_10:
    s_cbranch_vccnz L_pad_c_11
    ds_read_b128 v[52:55], v2 offset:16640
    s_waitcnt lgkmcnt(2)
    v_mfma_f32_32x32x16_bf16 v[24:39], v[140:143], v[44:47], v[24:39]
    ds_read_b128 v[40:43], v2 offset:17920
    s_waitcnt lgkmcnt(2)
    v_mfma_f32_32x32x16_bf16 v[24:39], v[144:147], v[48:51], v[24:39]
L_pad_c_11:
    s_cbranch_vccnz L_pad_c_12
    ds_read_b128 v[44:47], v2 offset:19200
    s_waitcnt lgkmcnt(2)
    v_mfma_f32_32x32x16_bf16 v[24:39], v[148:151], v[52:55], v[24:39]
L_pad_c_12:
    s_cbranch_vccnz L_pad_c_13
    ds_read_b128 v[48:51], v2 offset:20480
    ds_write_b128 v3, v[8:11] offset:0
    ds_write_b128 v3, v[12:15] offset:1024
    ds_write_b128 v3, v[16:19] offset:2048
    ds_write_b128 v3, v[20:23] offset:3072
    s_waitcnt lgkmcnt(6)
    v_mfma_f32_32x32x16_bf16 v[24:39], v[152:155], v[40:43], v[24:39]
L_pad_c_13:
    s_cbranch_vccnz L_pad_c_14
    ds_read_b128 v[52:55], v2 offset:21760
    s_waitcnt lgkmcnt(6)
    v_mfma_f32_32x32x16_bf16 v[24:39], v[156:159], v[44:47], v[24:39]
    ds_read_b128 v[40:43], v2 offset:23040
    s_waitcnt lgkmcnt(2)
    v_mfma_f32_32x32x16_bf16 v[24:39], v[160:163], v[48:51], v[24:39]
L_pad_c_14:
    s_cbranch_vccnz L_pad_c_15
    ds_read_b128 v[44:47], v2 offset:24320
    s_waitcnt lgkmcnt(2)
    v_mfma_f32_32x32x16_bf16 v[24:39], v[164:167], v[52:55], v[24:39]
    ds_read_b128 v[48:51], v2 offset:25600
    s_waitcnt lgkmcnt(2)
    v_mfma_f32_32x32x16_bf16 v[24:39], v[168:171], v[40:43], v[24:39]
L_pad_c_15:
    s_cbranch_vccnz L_pad_c_16
    ds_read_b128 v[52:55], v2 offset:26880
    s_waitcnt lgkmcnt(2)
    v_mfma_f32_32x32x16_bf16 v[24:39], v[172:175], v[44:47], v[24:39]
    ds_read_b128 v[40:43], v2 offset:28160
    s_waitcnt lgkmcnt(2)
    v_mfma_f32_32x32x16_bf16 v[24:39], v[176:179], v[48:51], v[24:39]
L_pad_c_16:
    s_cbranch_vccnz L_pad_c_17
    ds_read_b128 v[44:47], v2 offset:29440
    s_waitcnt lgkmcnt(2)
    v_mfma_f32_32x32x16_bf16 v[24:39], v[180:183], v[52:55], v[24:39]
    ds_read_b128 v[48:51], v2 offset:30720
    s_waitcnt lgkmcnt(2)
    v_mfma_f32_32x32x16_bf16 v[24:39], v[184:187], v[40:43], v[24:39]
L_pad_c_17:
    s_cbranch_vccnz L_pad_c_18
    ds_read_b128 v[52:55], v2 offset:32000
    s_barrier
    ds_read_b128 v[8:11], v1 offset:0
    ds_read_b128 v[12:15], v1 offset:4096
    ds_read_b128 v[16:19], v1 offset:8192
    ds_read_b128 v[20:23], v1 offset:12288
    s_waitcnt lgkmcnt(6)
    v_mfma_f32_32x32x16_bf16 v[24:39], v[188:191], v[44:47], v[24:39]
    ds_read_b128 v[40:43], v2 offset:33280
    s_waitcnt lgkmcnt(6)
    v_mfma_f32_32x32x16_bf16 v[24:39], v[192:195], v[48:51], v[24:39]
L_pad_c_18:
    s_cbranch_vccnz L_pad_c_19
    ds_read_b128 v[44:47], v2 offset:34560
    s_waitcnt lgkmcnt(2)
    v_mfma_f32_32x32x16_bf16 v[24:39], v[196:199], v[52:55], v[24:39]
    ds_read_b128 v[48:51], v2 offset:35840
    s_waitcnt lgkmcnt(2)
    v_mfma_f32_32x32x16_bf16 v[24:39], v[200:203], v[40:43], v[24:39]
L_pad_c_19:
    s_cbranch_vccnz L_pad_c_20
    ds_read_b128 v[52:55], v2 offset:37120
    s_waitcnt lgkmcnt(2)
    v_mfma_f32_32x32x16_bf16 v[24:39], v[204:207], v[44:47], v[24:39]
    ds_read_b128 v[40:43], v2 offset:38400
    s_waitcnt lgkmcnt(2)
    v_mfma_f32_32x32x16_bf16 v[24:39], v[208:211], v[48:51], v[24:39]
L_pad_c_20:
    s_cbranch_vccnz L_pad_c_21
    ds_read_b128 v[44:47], v2 offset:39680
    v_pk_add_f32 v[8:9], v[8:9], v[12:13]
    v_pk_add_f32 v[10:11], v[10:11], v[14:15]
    v_pk_add_f32 v[8:9], v[8:9], v[16:17]
    v_pk_add_f32 v[10:11], v[10:11], v[18:19]
    v_pk_add_f32 v[8:9], v[8:9], v[20:21]
    v_pk_add_f32 v[10:11], v[10:11], v[22:23]
    s_waitcnt lgkmcnt(2)
    v_mfma_f32_32x32x16_bf16 v[24:39], v[212:215], v[52:55], v[24:39]
    ds_read_b64 v[48:49], v5 offset:0
    ds_read_b64 v[50:51], v5 offset:1280
    s_waitcnt lgkmcnt(3)
    v_mfma_f32_32x32x16_bf16 v[24:39], v[216:219], v[40:43], v[24:39]
L_pad_c_21:
    s_cbranch_vccnz L_pad_c_22
    ds_read_b64 v[52:53], v5 offset:5120
    ds_read_b64 v[54:55], v5 offset:6400
    v_cvt_pk_bf16_f32 v8, v8, v9
    v_cvt_pk_bf16_f32 v9, v10, v11
    buffer_store_dwordx2 v[8:9], v0, s[32:35], s45 offen offset:256
    s_waitcnt lgkmcnt(4)
    v_mfma_f32_32x32x16_bf16 v[24:39], v[220:223], v[44:47], v[24:39]
    ds_read_b64 v[40:41], v5 offset:10240
    ds_read_b64 v[42:43], v5 offset:11520
    s_waitcnt lgkmcnt(4)
    v_mfma_f32_32x32x16_bf16 v[24:39], v[224:227], v[48:51], v[24:39]
L_pad_c_22:
    s_cbranch_vccnz L_pad_c_23
    ds_read_b64 v[44:45], v5 offset:15360
    ds_read_b64 v[46:47], v5 offset:16640
    s_waitcnt lgkmcnt(4)
    v_mfma_f32_32x32x16_bf16 v[24:39], v[228:231], v[52:55], v[24:39]
    ds_read_b64 v[48:49], v5 offset:20480
    ds_read_b64 v[50:51], v5 offset:21760
    s_waitcnt lgkmcnt(4)
    v_mfma_f32_32x32x16_bf16 v[24:39], v[232:235], v[40:43], v[24:39]
L_pad_c_23:
    s_cbranch_vccnz L_pad_c_24
    ds_read_b64 v[52:53], v5 offset:25600
    ds_read_b64 v[54:55], v5 offset:26880
    s_waitcnt lgkmcnt(4)
    v_mfma_f32_32x32x16_bf16 v[24:39], v[236:239], v[44:47], v[24:39]
    ds_read_b64 v[40:41], v5 offset:30720
    ds_read_b64 v[42:43], v5 offset:32000
    s_waitcnt lgkmcnt(4)
    v_mfma_f32_32x32x16_bf16 v[24:39], v[240:243], v[48:51], v[24:39]
L_pad_c_24:
    s_cbranch_vccnz L_pad_c_25
    ds_read_b64 v[44:45], v5 offset:35840
    ds_read_b64 v[46:47], v5 offset:37120
    s_waitcnt lgkmcnt(4)
    v_mfma_f32_32x32x16_bf16 v[24:39], v[244:247], v[52:55], v[24:39]
    s_waitcnt lgkmcnt(2)
    v_mfma_f32_32x32x16_bf16 v[24:39], v[248:251], v[40:43], v[24:39]
L_pad_c_25:
    s_cbranch_vccnz L_pad_z_0
    s_waitcnt lgkmcnt(0)
    v_mfma_f32_32x32x16_bf16 v[24:39], v[252:255], v[44:47], v[24:39]
L_tail_join:
L_pad_z_0:
    s_cbranch_vccnz L_pad_z_1
    s_nop 11
    v_cvt_pk_bf16_f32 v24, v24, v25
    v_cvt_pk_bf16_f32 v25, v26, v27
    v_cvt_pk_bf16_f32 v26, v28, v29
    v_cvt_pk_bf16_f32 v27, v30, v31
    v_cvt_pk_bf16_f32 v28, v32, v33
    v_cvt_pk_bf16_f32 v29, v34, v35
    v_cvt_pk_bf16_f32 v30, v36, v37
    v_cvt_pk_bf16_f32 v31, v38, v39
L_pad_z_1:
    s_cbranch_vccnz L_pad_ret
    s_nop 1
    v_permlane32_swap_b32 v24, v26
    v_permlane32_swap_b32 v25, v27
    v_permlane32_swap_b32 v28, v30
    v_permlane32_swap_b32 v29, v31
    buffer_store_dwordx4 v[24:27], v6, s[32:35], s43 offen offset:0
    buffer_store_dwordx4 v[28:31], v6, s[32:35], s43 offen offset:32
L_end:
L_exit:
    s_endpgm
.section .rodata,"a"
.p2align 6
.amdhsa_kernel concat_heads__mha_block__spectral_fnet__prompt_kernel
  .amdhsa_next_free_vgpr 256
  .amdhsa_next_free_sgpr 102
  .amdhsa_accum_offset 256
  .amdhsa_group_segment_fixed_size 0
  .amdhsa_kernarg_size 88
  .amdhsa_user_sgpr_count 2
  .amdhsa_user_sgpr_kernarg_segment_ptr 1
  .amdhsa_system_sgpr_workgroup_id_x 1
.end_amdhsa_kernel
```
